```python
import torch

def _softmax(x, axis=-1):
    return torch.softmax(x, dim=axis)
def _gelu(x):
    return torch.nn.functional.gelu(x, approximate="tanh")
def _silu(x):
    return torch.nn.functional.silu(x)
def _sigmoid(x):
    return torch.sigmoid(x)
def _layernorm(x, axis=-1, eps=1e-5):
    m = x.mean(dim=axis, keepdim=True)
    v = x.var(dim=axis, keepdim=True, unbiased=False)
    return (x - m) / torch.sqrt(v + eps)
def _scatter_add(tgt, idx, src, axis=0):
    return tgt.clone().index_add_(axis, idx, src)
def _segment_sum(src, seg, n):
    out = torch.zeros((n,) + src.shape[1:], dtype=src.dtype)
    return out.index_add_(0, seg, src)
def _pad(x, pw):
    flat = tuple(v for pair in reversed(pw) for v in pair)
    return torch.nn.functional.pad(x, flat)

kernel_name = 'concat_heads__grouped_kv_mqa__sliding_local_dilated__prompt'

def setup_inputs():

    _w = (lambda a: (lambda t: t.to(torch.bfloat16) if t.is_floating_point() else t)(torch.as_tensor(a)))
    def _A_setup():
        B, S, D, H = 1, 2048, 448, 16
        Dh = D // H
        return {
            "x": _w((lambda *s: torch.randn(*s, dtype=torch.bfloat16) * 0.05)(B, S, D)),
            "wq": _w((lambda *s: torch.randn(*s, dtype=torch.bfloat16) * 3.2)(D, H * Dh)),
            "wk": _w((lambda *s: torch.randn(*s, dtype=torch.bfloat16) * 3.2)(D, Dh)),
            "wv": _w((lambda *s: torch.randn(*s, dtype=torch.bfloat16) * 1.6)(D, Dh)),
            "wo": _w((lambda *s: torch.randn(*s, dtype=torch.bfloat16) * 1.6)(H * Dh, D)),
        }
    _A_in = _A_setup()

    def _B_setup():
        B, S, D = 1, 2048, 448
        return {
            "x": _w((lambda *s: torch.randn(*s, dtype=torch.bfloat16) * 0.1)(B, S, D)),
            "wqkv": _w((lambda *s: torch.randn(*s, dtype=torch.bfloat16) * 0.8)(D, 3 * D)),
            "wo": _w((lambda *s: torch.randn(*s, dtype=torch.bfloat16) * 0.8)(D, D)),
        }
    _B_in = _B_setup()

    return {
        "A_x": _A_in["x"],
        "A_wq": _A_in["wq"],
        "A_wk": _A_in["wk"],
        "A_wv": _A_in["wv"],
        "A_wo": _A_in["wo"],
        "B_x": _B_in["x"],
        "B_wqkv": _B_in["wqkv"],
        "B_wo": _B_in["wo"],
    }

def reference(A_x, A_wq, A_wk, A_wv, A_wo, B_x, B_wqkv, B_wo):
    def _A_ref(x, wq, wk, wv, wo):
        B, S, D = x.shape
        H = 16
        Dh = D // H
        q = (lambda x, *d: x.permute(*d))((x @ wq).reshape(B, S, H, Dh), 0, 2, 1, 3)
        k = x @ wk
        v = x @ wv
        scores = torch.einsum("bhqd,bkd->bhqk", q, k) * (Dh ** -0.5)
        p = _softmax(scores, axis=-1)
        o = torch.einsum("bhqk,bkd->bhqd", p, v)
        return (lambda x, *d: x.permute(*d))(o, 0, 2, 1, 3).reshape(B, S, H * Dh) @ wo

    def _B_ref(x, wqkv, wo):
        B, S, D = x.shape
        H = 16; Dh = D // H
        W, dil = 8, 2
        qkv = (lambda x, *d: x.permute(*d))((x @ wqkv).reshape(B, S, 3, H, Dh), 2, 0, 3, 1, 4)
        q, k, v = qkv[0], qkv[1], qkv[2]
        scale = Dh ** -0.5
        pos = torch.arange(S)
        off = torch.arange(W) * dil
        idx = pos[:, None] - off[None, :]
        mask = idx >= 0
        idx_c = torch.where(mask, idx, 0).reshape(-1)
        kg = k[:, :, idx_c, :].reshape(B, H, S, W, Dh)
        vg = v[:, :, idx_c, :].reshape(B, H, S, W, Dh)
        logits = torch.einsum("bhsd,bhswd->bhsw", q, kg) * scale
        logits = torch.where(mask[None, None, :, :], logits, -1e9)
        attn = _softmax(logits, axis=-1)
        o = torch.einsum("bhsw,bhswd->bhsd", attn, vg)
        return (lambda x, *d: x.permute(*d))(o, 0, 2, 1, 3).reshape(B, S, D) @ wo

    a = _A_ref(A_x, A_wq, A_wk, A_wv, A_wo)
    b = _B_ref(B_x, B_wqkv, B_wo)
    return torch.concatenate([a, b], axis=-1)
```

```asm
; @launch kernel=k1_proj_kernel grid=(256,1,1) block=(256,1,1) lds=120320
; @launch kernel=k2_attn_kernel grid=(256,1,1) block=(640,1,1) lds=131072
; @launch kernel=k3_out_kernel grid=(128,1,1) block=(256,1,1) lds=120320
.amdgcn_target "amdgcn-amd-amdhsa--gfx950"
.text
.globl k1_proj_kernel
.p2align 8
.type k1_proj_kernel,@function
k1_proj_kernel:
    s_cmp_ge_u32 s2, 256
    s_cbranch_scc1 k1_exit
    s_load_dwordx16 s[4:19], s[0:1], 0
    s_load_dwordx2 s[20:21], s[0:1], 80
    s_and_b32 s22, s2, 15
    s_lshr_b32 s23, s2, 4
    s_lshl_b32 s41, s23, 7
    s_waitcnt lgkmcnt(0)
    s_cmp_eq_u32 s22, 4
    s_cbranch_scc1 k1_kv
    s_cmp_gt_u32 s22, 4
    s_cbranch_scc1 k1_b
    s_add_u32 s24, s4, 0x0
    s_addc_u32 s25, s5, 0
    s_and_b32 s25, s25, 0xffff
    s_mov_b32 s26, 0x1c0000
    s_mov_b32 s27, 0x00020000
    s_add_u32 s28, s6, 0x0
    s_addc_u32 s29, s7, 0
    s_and_b32 s29, s29, 0xffff
    s_mov_b32 s30, 0x62000
    s_mov_b32 s31, 0x00020000
    s_add_u32 s32, s20, 0x0
    s_addc_u32 s33, s21, 0
    s_and_b32 s33, s33, 0xffff
    s_mov_b32 s34, 0x1c0000
    s_mov_b32 s35, 0x00020000
    s_mov_b32 s36, 896
    s_mov_b32 s37, 896
    s_lshl_b32 s38, s22, 7
    s_mov_b32 s39, 448
    s_branch k1_main
k1_b:
    s_add_u32 s24, s14, 0x0
    s_addc_u32 s25, s15, 0
    s_and_b32 s25, s25, 0xffff
    s_mov_b32 s26, 0x1c0000
    s_mov_b32 s27, 0x00020000
    s_add_u32 s28, s16, 0x0
    s_addc_u32 s29, s17, 0
    s_and_b32 s29, s29, 0xffff
    s_mov_b32 s30, 0x126000
    s_mov_b32 s31, 0x00020000
    s_add_u32 s32, s20, 0x300000
    s_addc_u32 s33, s21, 0
    s_and_b32 s33, s33, 0xffff
    s_mov_b32 s34, 0x540000
    s_mov_b32 s35, 0x00020000
    s_mov_b32 s36, 2688
    s_mov_b32 s37, 2688
    s_sub_u32 s38, s22, 5
    s_lshl_b32 s38, s38, 7
    s_mov_b32 s39, 1344
k1_main:
    v_lshrrev_b32 v7, 5, v0
    v_and_b32 v8, 31, v0
    v_add_u32 v9, s41, v7
    s_mov_b32 s40, 896
    v_mul_lo_u32 v1, v9, s40
    v_lshl_add_u32 v1, v8, 4, v1
    s_mov_b32 s40, 464
    v_mul_lo_u32 v2, v7, s40
    v_lshl_add_u32 v2, v8, 4, v2
    v_cmp_gt_u32 s[42:43], 28, v8
    v_lshrrev_b32 v7, 4, v0
    v_and_b32 v8, 15, v0
    s_mov_b32 s40, 272
    v_mul_lo_u32 v4, v7, s40
    v_mul_lo_u32 v3, v7, s36
    v_lshl_add_u32 v3, v8, 4, v3
    s_lshl_b32 s40, s38, 1
    v_add_u32 v3, s40, v3
    v_lshl_add_u32 v4, v8, 4, v4
    v_add_u32 v4, 59392, v4
    s_mov_b32 s40, 0
    buffer_load_dwordx4 v[16:19], v1, s[24:27], s40 offen
    s_mov_b32 s40, 7168
    buffer_load_dwordx4 v[20:23], v1, s[24:27], s40 offen
    s_mov_b32 s40, 14336
    buffer_load_dwordx4 v[24:27], v1, s[24:27], s40 offen
    s_mov_b32 s40, 21504
    buffer_load_dwordx4 v[28:31], v1, s[24:27], s40 offen
    s_mov_b32 s40, 28672
    buffer_load_dwordx4 v[32:35], v1, s[24:27], s40 offen
    s_mov_b32 s40, 35840
    buffer_load_dwordx4 v[36:39], v1, s[24:27], s40 offen
    s_mov_b32 s40, 43008
    buffer_load_dwordx4 v[40:43], v1, s[24:27], s40 offen
    s_mov_b32 s40, 50176
    buffer_load_dwordx4 v[44:47], v1, s[24:27], s40 offen
    s_mov_b32 s40, 57344
    buffer_load_dwordx4 v[48:51], v1, s[24:27], s40 offen
    s_mov_b32 s40, 64512
    buffer_load_dwordx4 v[52:55], v1, s[24:27], s40 offen
    s_mov_b32 s40, 71680
    buffer_load_dwordx4 v[56:59], v1, s[24:27], s40 offen
    s_mov_b32 s40, 78848
    buffer_load_dwordx4 v[60:63], v1, s[24:27], s40 offen
    s_mov_b32 s40, 86016
    buffer_load_dwordx4 v[64:67], v1, s[24:27], s40 offen
    s_mov_b32 s40, 93184
    buffer_load_dwordx4 v[68:71], v1, s[24:27], s40 offen
    s_mov_b32 s40, 100352
    buffer_load_dwordx4 v[72:75], v1, s[24:27], s40 offen
    s_mov_b32 s40, 107520
    buffer_load_dwordx4 v[76:79], v1, s[24:27], s40 offen
    s_mul_i32 s40, s36, 0
    buffer_load_dwordx4 v[80:83], v3, s[28:31], s40 offen
    s_mul_i32 s40, s36, 16
    buffer_load_dwordx4 v[84:87], v3, s[28:31], s40 offen
    s_mul_i32 s40, s36, 32
    buffer_load_dwordx4 v[88:91], v3, s[28:31], s40 offen
    s_mul_i32 s40, s36, 48
    buffer_load_dwordx4 v[92:95], v3, s[28:31], s40 offen
    s_mul_i32 s40, s36, 64
    buffer_load_dwordx4 v[96:99], v3, s[28:31], s40 offen
    s_mul_i32 s40, s36, 80
    buffer_load_dwordx4 v[100:103], v3, s[28:31], s40 offen
    s_mul_i32 s40, s36, 96
    buffer_load_dwordx4 v[104:107], v3, s[28:31], s40 offen
    s_mul_i32 s40, s36, 112
    buffer_load_dwordx4 v[108:111], v3, s[28:31], s40 offen
    s_mul_i32 s40, s36, 128
    buffer_load_dwordx4 v[112:115], v3, s[28:31], s40 offen
    s_mul_i32 s40, s36, 144
    buffer_load_dwordx4 v[116:119], v3, s[28:31], s40 offen
    s_mul_i32 s40, s36, 160
    buffer_load_dwordx4 v[120:123], v3, s[28:31], s40 offen
    s_mul_i32 s40, s36, 176
    buffer_load_dwordx4 v[124:127], v3, s[28:31], s40 offen
    s_mul_i32 s40, s36, 192
    buffer_load_dwordx4 v[128:131], v3, s[28:31], s40 offen
    s_mul_i32 s40, s36, 208
    buffer_load_dwordx4 v[132:135], v3, s[28:31], s40 offen
    v_lshrrev_b32 v7, 6, v0
    v_and_b32 v8, 63, v0
    v_and_b32 v9, 31, v8
    v_lshrrev_b32 v10, 5, v8
    v_lshrrev_b32 v11, 1, v7
    v_and_b32 v12, 1, v7
    v_lshl_add_u32 v13, v11, 6, v9
    s_mov_b32 s40, 464
    v_mul_lo_u32 v5, v13, s40
    v_lshl_add_u32 v5, v10, 4, v5
    v_bfe_u32 v14, v8, 2, 2
    v_lshl_add_u32 v14, v10, 3, v14
    s_mov_b32 s40, 272
    v_mul_lo_u32 v6, v14, s40
    v_bfe_u32 v14, v8, 4, 1
    v_lshlrev_b32 v14, 5, v14
    v_lshl_add_u32 v14, v12, 7, v14
    v_and_b32 v15, 3, v8
    v_lshl_add_u32 v14, v15, 3, v14
    v_add_u32 v6, v6, v14
    v_add_u32 v6, 59392, v6
    v_mov_b32 v136, 0
    v_mov_b32 v137, 0
    v_mov_b32 v138, 0
    v_mov_b32 v139, 0
    v_mov_b32 v140, 0
    v_mov_b32 v141, 0
    v_mov_b32 v142, 0
    v_mov_b32 v143, 0
    v_mov_b32 v144, 0
    v_mov_b32 v145, 0
    v_mov_b32 v146, 0
    v_mov_b32 v147, 0
    v_mov_b32 v148, 0
    v_mov_b32 v149, 0
    v_mov_b32 v150, 0
    v_mov_b32 v151, 0
    v_mov_b32 v152, 0
    v_mov_b32 v153, 0
    v_mov_b32 v154, 0
    v_mov_b32 v155, 0
    v_mov_b32 v156, 0
    v_mov_b32 v157, 0
    v_mov_b32 v158, 0
    v_mov_b32 v159, 0
    v_mov_b32 v160, 0
    v_mov_b32 v161, 0
    v_mov_b32 v162, 0
    v_mov_b32 v163, 0
    v_mov_b32 v164, 0
    v_mov_b32 v165, 0
    v_mov_b32 v166, 0
    v_mov_b32 v167, 0
    v_mov_b32 v168, 0
    v_mov_b32 v169, 0
    v_mov_b32 v170, 0
    v_mov_b32 v171, 0
    v_mov_b32 v172, 0
    v_mov_b32 v173, 0
    v_mov_b32 v174, 0
    v_mov_b32 v175, 0
    v_mov_b32 v176, 0
    v_mov_b32 v177, 0
    v_mov_b32 v178, 0
    v_mov_b32 v179, 0
    v_mov_b32 v180, 0
    v_mov_b32 v181, 0
    v_mov_b32 v182, 0
    v_mov_b32 v183, 0
    v_mov_b32 v184, 0
    v_mov_b32 v185, 0
    v_mov_b32 v186, 0
    v_mov_b32 v187, 0
    v_mov_b32 v188, 0
    v_mov_b32 v189, 0
    v_mov_b32 v190, 0
    v_mov_b32 v191, 0
    v_mov_b32 v192, 0
    v_mov_b32 v193, 0
    v_mov_b32 v194, 0
    v_mov_b32 v195, 0
    v_mov_b32 v196, 0
    v_mov_b32 v197, 0
    v_mov_b32 v198, 0
    v_mov_b32 v199, 0
    s_waitcnt vmcnt(0)
    s_mov_b64 exec, s[42:43]
    ds_write_b128 v2, v[16:19] offset:0
    ds_write_b128 v2, v[20:23] offset:3712
    ds_write_b128 v2, v[24:27] offset:7424
    ds_write_b128 v2, v[28:31] offset:11136
    ds_write_b128 v2, v[32:35] offset:14848
    ds_write_b128 v2, v[36:39] offset:18560
    ds_write_b128 v2, v[40:43] offset:22272
    ds_write_b128 v2, v[44:47] offset:25984
    ds_write_b128 v2, v[48:51] offset:29696
    ds_write_b128 v2, v[52:55] offset:33408
    ds_write_b128 v2, v[56:59] offset:37120
    ds_write_b128 v2, v[60:63] offset:40832
    ds_write_b128 v2, v[64:67] offset:44544
    ds_write_b128 v2, v[68:71] offset:48256
    ds_write_b128 v2, v[72:75] offset:51968
    ds_write_b128 v2, v[76:79] offset:55680
    s_mov_b64 exec, -1
    ds_write_b128 v4, v[80:83] offset:0
    ds_write_b128 v4, v[84:87] offset:4352
    ds_write_b128 v4, v[88:91] offset:8704
    ds_write_b128 v4, v[92:95] offset:13056
    ds_write_b128 v4, v[96:99] offset:17408
    ds_write_b128 v4, v[100:103] offset:21760
    ds_write_b128 v4, v[104:107] offset:26112
    ds_write_b128 v4, v[108:111] offset:30464
    ds_write_b128 v4, v[112:115] offset:34816
    ds_write_b128 v4, v[116:119] offset:39168
    ds_write_b128 v4, v[120:123] offset:43520
    ds_write_b128 v4, v[124:127] offset:47872
    ds_write_b128 v4, v[128:131] offset:52224
    ds_write_b128 v4, v[132:135] offset:56576
    s_waitcnt lgkmcnt(0)
    s_barrier
    s_mov_b32 s40, 448
    buffer_load_dwordx4 v[16:19], v1, s[24:27], s40 offen
    s_mov_b32 s40, 7616
    buffer_load_dwordx4 v[20:23], v1, s[24:27], s40 offen
    s_mov_b32 s40, 14784
    buffer_load_dwordx4 v[24:27], v1, s[24:27], s40 offen
    s_mov_b32 s40, 21952
    buffer_load_dwordx4 v[28:31], v1, s[24:27], s40 offen
    s_mov_b32 s40, 29120
    buffer_load_dwordx4 v[32:35], v1, s[24:27], s40 offen
    s_mov_b32 s40, 36288
    buffer_load_dwordx4 v[36:39], v1, s[24:27], s40 offen
    s_mov_b32 s40, 43456
    buffer_load_dwordx4 v[40:43], v1, s[24:27], s40 offen
    s_mov_b32 s40, 50624
    buffer_load_dwordx4 v[44:47], v1, s[24:27], s40 offen
    s_mov_b32 s40, 57792
    buffer_load_dwordx4 v[48:51], v1, s[24:27], s40 offen
    s_mov_b32 s40, 64960
    buffer_load_dwordx4 v[52:55], v1, s[24:27], s40 offen
    s_mov_b32 s40, 72128
    buffer_load_dwordx4 v[56:59], v1, s[24:27], s40 offen
    s_mov_b32 s40, 79296
    buffer_load_dwordx4 v[60:63], v1, s[24:27], s40 offen
    s_mov_b32 s40, 86464
    buffer_load_dwordx4 v[64:67], v1, s[24:27], s40 offen
    s_mov_b32 s40, 93632
    buffer_load_dwordx4 v[68:71], v1, s[24:27], s40 offen
    s_mov_b32 s40, 100800
    buffer_load_dwordx4 v[72:75], v1, s[24:27], s40 offen
    s_mov_b32 s40, 107968
    buffer_load_dwordx4 v[76:79], v1, s[24:27], s40 offen
    s_mul_i32 s40, s36, 224
    buffer_load_dwordx4 v[80:83], v3, s[28:31], s40 offen
    s_mul_i32 s40, s36, 240
    buffer_load_dwordx4 v[84:87], v3, s[28:31], s40 offen
    s_mul_i32 s40, s36, 256
    buffer_load_dwordx4 v[88:91], v3, s[28:31], s40 offen
    s_mul_i32 s40, s36, 272
    buffer_load_dwordx4 v[92:95], v3, s[28:31], s40 offen
    s_mul_i32 s40, s36, 288
    buffer_load_dwordx4 v[96:99], v3, s[28:31], s40 offen
    s_mul_i32 s40, s36, 304
    buffer_load_dwordx4 v[100:103], v3, s[28:31], s40 offen
    s_mul_i32 s40, s36, 320
    buffer_load_dwordx4 v[104:107], v3, s[28:31], s40 offen
    s_mul_i32 s40, s36, 336
    buffer_load_dwordx4 v[108:111], v3, s[28:31], s40 offen
    s_mul_i32 s40, s36, 352
    buffer_load_dwordx4 v[112:115], v3, s[28:31], s40 offen
    s_mul_i32 s40, s36, 368
    buffer_load_dwordx4 v[116:119], v3, s[28:31], s40 offen
    s_mul_i32 s40, s36, 384
    buffer_load_dwordx4 v[120:123], v3, s[28:31], s40 offen
    s_mul_i32 s40, s36, 400
    buffer_load_dwordx4 v[124:127], v3, s[28:31], s40 offen
    s_mul_i32 s40, s36, 416
    buffer_load_dwordx4 v[128:131], v3, s[28:31], s40 offen
    s_mul_i32 s40, s36, 432
    buffer_load_dwordx4 v[132:135], v3, s[28:31], s40 offen
    v_mov_b32 v232, v5
    v_mov_b32 v233, v6
    s_mov_b32 s50, 0
    ds_read_b128 v[200:203], v232 offset:0
    ds_read_b128 v[204:207], v232 offset:14848
    ds_read_b64_tr_b16 v[208:209], v233 offset:0
    ds_read_b64_tr_b16 v[210:211], v233 offset:1088
    ds_read_b64_tr_b16 v[212:213], v233 offset:64
    ds_read_b64_tr_b16 v[214:215], v233 offset:1152
gk1:
    ds_read_b128 v[216:219], v232 offset:32
    ds_read_b128 v[220:223], v232 offset:14880
    ds_read_b64_tr_b16 v[224:225], v233 offset:4352
    ds_read_b64_tr_b16 v[226:227], v233 offset:5440
    ds_read_b64_tr_b16 v[228:229], v233 offset:4416
    ds_read_b64_tr_b16 v[230:231], v233 offset:5504
    s_waitcnt lgkmcnt(6)
    v_mfma_f32_32x32x16_bf16 v[136:151], v[208:211], v[200:203], v[136:151]
    v_mfma_f32_32x32x16_bf16 v[152:167], v[212:215], v[200:203], v[152:167]
    v_mfma_f32_32x32x16_bf16 v[168:183], v[208:211], v[204:207], v[168:183]
    v_mfma_f32_32x32x16_bf16 v[184:199], v[212:215], v[204:207], v[184:199]
    ds_read_b128 v[200:203], v232 offset:64
    ds_read_b128 v[204:207], v232 offset:14912
    ds_read_b64_tr_b16 v[208:209], v233 offset:8704
    ds_read_b64_tr_b16 v[210:211], v233 offset:9792
    ds_read_b64_tr_b16 v[212:213], v233 offset:8768
    ds_read_b64_tr_b16 v[214:215], v233 offset:9856
    s_waitcnt lgkmcnt(6)
    v_mfma_f32_32x32x16_bf16 v[136:151], v[224:227], v[216:219], v[136:151]
    v_mfma_f32_32x32x16_bf16 v[152:167], v[228:231], v[216:219], v[152:167]
    v_mfma_f32_32x32x16_bf16 v[168:183], v[224:227], v[220:223], v[168:183]
    v_mfma_f32_32x32x16_bf16 v[184:199], v[228:231], v[220:223], v[184:199]
    v_add_u32 v232, 64, v232
    v_add_u32 v233, 8704, v233
    s_add_u32 s50, s50, 1
    s_cmp_lt_u32 s50, 7
    s_cbranch_scc1 gk1
    s_waitcnt lgkmcnt(0)
    s_barrier
    s_waitcnt vmcnt(0)
    s_mov_b64 exec, s[42:43]
    ds_write_b128 v2, v[16:19] offset:0
    ds_write_b128 v2, v[20:23] offset:3712
    ds_write_b128 v2, v[24:27] offset:7424
    ds_write_b128 v2, v[28:31] offset:11136
    ds_write_b128 v2, v[32:35] offset:14848
    ds_write_b128 v2, v[36:39] offset:18560
    ds_write_b128 v2, v[40:43] offset:22272
    ds_write_b128 v2, v[44:47] offset:25984
    ds_write_b128 v2, v[48:51] offset:29696
    ds_write_b128 v2, v[52:55] offset:33408
    ds_write_b128 v2, v[56:59] offset:37120
    ds_write_b128 v2, v[60:63] offset:40832
    ds_write_b128 v2, v[64:67] offset:44544
    ds_write_b128 v2, v[68:71] offset:48256
    ds_write_b128 v2, v[72:75] offset:51968
    ds_write_b128 v2, v[76:79] offset:55680
    s_mov_b64 exec, -1
    ds_write_b128 v4, v[80:83] offset:0
    ds_write_b128 v4, v[84:87] offset:4352
    ds_write_b128 v4, v[88:91] offset:8704
    ds_write_b128 v4, v[92:95] offset:13056
    ds_write_b128 v4, v[96:99] offset:17408
    ds_write_b128 v4, v[100:103] offset:21760
    ds_write_b128 v4, v[104:107] offset:26112
    ds_write_b128 v4, v[108:111] offset:30464
    ds_write_b128 v4, v[112:115] offset:34816
    ds_write_b128 v4, v[116:119] offset:39168
    ds_write_b128 v4, v[120:123] offset:43520
    ds_write_b128 v4, v[124:127] offset:47872
    ds_write_b128 v4, v[128:131] offset:52224
    ds_write_b128 v4, v[132:135] offset:56576
    s_waitcnt lgkmcnt(0)
    s_barrier
    v_mov_b32 v232, v5
    v_mov_b32 v233, v6
    s_mov_b32 s50, 0
    ds_read_b128 v[200:203], v232 offset:0
    ds_read_b128 v[204:207], v232 offset:14848
    ds_read_b64_tr_b16 v[208:209], v233 offset:0
    ds_read_b64_tr_b16 v[210:211], v233 offset:1088
    ds_read_b64_tr_b16 v[212:213], v233 offset:64
    ds_read_b64_tr_b16 v[214:215], v233 offset:1152
gk2:
    ds_read_b128 v[216:219], v232 offset:32
    ds_read_b128 v[220:223], v232 offset:14880
    ds_read_b64_tr_b16 v[224:225], v233 offset:4352
    ds_read_b64_tr_b16 v[226:227], v233 offset:5440
    ds_read_b64_tr_b16 v[228:229], v233 offset:4416
    ds_read_b64_tr_b16 v[230:231], v233 offset:5504
    s_waitcnt lgkmcnt(6)
    v_mfma_f32_32x32x16_bf16 v[136:151], v[208:211], v[200:203], v[136:151]
    v_mfma_f32_32x32x16_bf16 v[152:167], v[212:215], v[200:203], v[152:167]
    v_mfma_f32_32x32x16_bf16 v[168:183], v[208:211], v[204:207], v[168:183]
    v_mfma_f32_32x32x16_bf16 v[184:199], v[212:215], v[204:207], v[184:199]
    ds_read_b128 v[200:203], v232 offset:64
    ds_read_b128 v[204:207], v232 offset:14912
    ds_read_b64_tr_b16 v[208:209], v233 offset:8704
    ds_read_b64_tr_b16 v[210:211], v233 offset:9792
    ds_read_b64_tr_b16 v[212:213], v233 offset:8768
    ds_read_b64_tr_b16 v[214:215], v233 offset:9856
    s_waitcnt lgkmcnt(6)
    v_mfma_f32_32x32x16_bf16 v[136:151], v[224:227], v[216:219], v[136:151]
    v_mfma_f32_32x32x16_bf16 v[152:167], v[228:231], v[216:219], v[152:167]
    v_mfma_f32_32x32x16_bf16 v[168:183], v[224:227], v[220:223], v[168:183]
    v_mfma_f32_32x32x16_bf16 v[184:199], v[228:231], v[220:223], v[184:199]
    v_add_u32 v232, 64, v232
    v_add_u32 v233, 8704, v233
    s_add_u32 s50, s50, 1
    s_cmp_lt_u32 s50, 7
    s_cbranch_scc1 gk2
    s_waitcnt lgkmcnt(0)
    s_nop 15
    s_nop 3
    v_add_u32 v16, s41, v13
    v_mul_lo_u32 v16, v16, s37
    v_lshlrev_b32 v17, 6, v12
    v_lshl_add_u32 v17, v10, 2, v17
    v_add_u32 v17, s38, v17
    v_lshl_add_u32 v16, v17, 1, v16
    s_lshl_b32 s40, s37, 5
    v_cvt_pk_bf16_f32 v20, v136, v137
    v_cvt_pk_bf16_f32 v21, v138, v139
    v_add_u32 v18, 0, v17
    v_cmp_gt_u32 vcc, s39, v18
    v_mov_b32 v19, 0x40000000
    s_nop 1
    v_cndmask_b32 v19, v19, v16, vcc
    buffer_store_dwordx2 v[20:21], v19, s[32:35], 0 offen offset:0
    s_nop 1
    v_cvt_pk_bf16_f32 v20, v140, v141
    v_cvt_pk_bf16_f32 v21, v142, v143
    v_add_u32 v18, 8, v17
    v_cmp_gt_u32 vcc, s39, v18
    v_mov_b32 v19, 0x40000000
    s_nop 1
    v_cndmask_b32 v19, v19, v16, vcc
    buffer_store_dwordx2 v[20:21], v19, s[32:35], 0 offen offset:16
    s_nop 1
    v_cvt_pk_bf16_f32 v20, v144, v145
    v_cvt_pk_bf16_f32 v21, v146, v147
    v_add_u32 v18, 16, v17
    v_cmp_gt_u32 vcc, s39, v18
    v_mov_b32 v19, 0x40000000
    s_nop 1
    v_cndmask_b32 v19, v19, v16, vcc
    buffer_store_dwordx2 v[20:21], v19, s[32:35], 0 offen offset:32
    s_nop 1
    v_cvt_pk_bf16_f32 v20, v148, v149
    v_cvt_pk_bf16_f32 v21, v150, v151
    v_add_u32 v18, 24, v17
    v_cmp_gt_u32 vcc, s39, v18
    v_mov_b32 v19, 0x40000000
    s_nop 1
    v_cndmask_b32 v19, v19, v16, vcc
    buffer_store_dwordx2 v[20:21], v19, s[32:35], 0 offen offset:48
    s_nop 1
    v_cvt_pk_bf16_f32 v20, v152, v153
    v_cvt_pk_bf16_f32 v21, v154, v155
    v_add_u32 v18, 32, v17
    v_cmp_gt_u32 vcc, s39, v18
    v_mov_b32 v19, 0x40000000
    s_nop 1
    v_cndmask_b32 v19, v19, v16, vcc
    buffer_store_dwordx2 v[20:21], v19, s[32:35], 0 offen offset:64
    s_nop 1
    v_cvt_pk_bf16_f32 v20, v156, v157
    v_cvt_pk_bf16_f32 v21, v158, v159
    v_add_u32 v18, 40, v17
    v_cmp_gt_u32 vcc, s39, v18
    v_mov_b32 v19, 0x40000000
    s_nop 1
    v_cndmask_b32 v19, v19, v16, vcc
    buffer_store_dwordx2 v[20:21], v19, s[32:35], 0 offen offset:80
    s_nop 1
    v_cvt_pk_bf16_f32 v20, v160, v161
    v_cvt_pk_bf16_f32 v21, v162, v163
    v_add_u32 v18, 48, v17
    v_cmp_gt_u32 vcc, s39, v18
    v_mov_b32 v19, 0x40000000
    s_nop 1
    v_cndmask_b32 v19, v19, v16, vcc
    buffer_store_dwordx2 v[20:21], v19, s[32:35], 0 offen offset:96
    s_nop 1
    v_cvt_pk_bf16_f32 v20, v164, v165
    v_cvt_pk_bf16_f32 v21, v166, v167
    v_add_u32 v18, 56, v17
    v_cmp_gt_u32 vcc, s39, v18
    v_mov_b32 v19, 0x40000000
    s_nop 1
    v_cndmask_b32 v19, v19, v16, vcc
    buffer_store_dwordx2 v[20:21], v19, s[32:35], 0 offen offset:112
    s_nop 1
    v_cvt_pk_bf16_f32 v20, v168, v169
    v_cvt_pk_bf16_f32 v21, v170, v171
    v_add_u32 v18, 0, v17
    v_cmp_gt_u32 vcc, s39, v18
    v_mov_b32 v19, 0x40000000
    s_nop 1
    v_cndmask_b32 v19, v19, v16, vcc
    buffer_store_dwordx2 v[20:21], v19, s[32:35], s40 offen offset:0
    s_nop 1
    v_cvt_pk_bf16_f32 v20, v172, v173
    v_cvt_pk_bf16_f32 v21, v174, v175
    v_add_u32 v18, 8, v17
    v_cmp_gt_u32 vcc, s39, v18
    v_mov_b32 v19, 0x40000000
    s_nop 1
    v_cndmask_b32 v19, v19, v16, vcc
    buffer_store_dwordx2 v[20:21], v19, s[32:35], s40 offen offset:16
    s_nop 1
    v_cvt_pk_bf16_f32 v20, v176, v177
    v_cvt_pk_bf16_f32 v21, v178, v179
    v_add_u32 v18, 16, v17
    v_cmp_gt_u32 vcc, s39, v18
    v_mov_b32 v19, 0x40000000
    s_nop 1
    v_cndmask_b32 v19, v19, v16, vcc
    buffer_store_dwordx2 v[20:21], v19, s[32:35], s40 offen offset:32
    s_nop 1
    v_cvt_pk_bf16_f32 v20, v180, v181
    v_cvt_pk_bf16_f32 v21, v182, v183
    v_add_u32 v18, 24, v17
    v_cmp_gt_u32 vcc, s39, v18
    v_mov_b32 v19, 0x40000000
    s_nop 1
    v_cndmask_b32 v19, v19, v16, vcc
    buffer_store_dwordx2 v[20:21], v19, s[32:35], s40 offen offset:48
    s_nop 1
    v_cvt_pk_bf16_f32 v20, v184, v185
    v_cvt_pk_bf16_f32 v21, v186, v187
    v_add_u32 v18, 32, v17
    v_cmp_gt_u32 vcc, s39, v18
    v_mov_b32 v19, 0x40000000
    s_nop 1
    v_cndmask_b32 v19, v19, v16, vcc
    buffer_store_dwordx2 v[20:21], v19, s[32:35], s40 offen offset:64
    s_nop 1
    v_cvt_pk_bf16_f32 v20, v188, v189
    v_cvt_pk_bf16_f32 v21, v190, v191
    v_add_u32 v18, 40, v17
    v_cmp_gt_u32 vcc, s39, v18
    v_mov_b32 v19, 0x40000000
    s_nop 1
    v_cndmask_b32 v19, v19, v16, vcc
    buffer_store_dwordx2 v[20:21], v19, s[32:35], s40 offen offset:80
    s_nop 1
    v_cvt_pk_bf16_f32 v20, v192, v193
    v_cvt_pk_bf16_f32 v21, v194, v195
    v_add_u32 v18, 48, v17
    v_cmp_gt_u32 vcc, s39, v18
    v_mov_b32 v19, 0x40000000
    s_nop 1
    v_cndmask_b32 v19, v19, v16, vcc
    buffer_store_dwordx2 v[20:21], v19, s[32:35], s40 offen offset:96
    s_nop 1
    v_cvt_pk_bf16_f32 v20, v196, v197
    v_cvt_pk_bf16_f32 v21, v198, v199
    v_add_u32 v18, 56, v17
    v_cmp_gt_u32 vcc, s39, v18
    v_mov_b32 v19, 0x40000000
    s_nop 1
    v_cndmask_b32 v19, v19, v16, vcc
    buffer_store_dwordx2 v[20:21], v19, s[32:35], s40 offen offset:112
    s_nop 1
    s_endpgm
k1_kv:
    s_add_u32 s24, s4, 0x0
    s_addc_u32 s25, s5, 0
    s_and_b32 s25, s25, 0xffff
    s_mov_b32 s26, 0x1c0000
    s_mov_b32 s27, 0x00020000
    s_add_u32 s28, s8, 0x0
    s_addc_u32 s29, s9, 0
    s_and_b32 s29, s29, 0xffff
    s_mov_b32 s30, 0x6200
    s_mov_b32 s31, 0x00020000
    s_add_u32 s44, s10, 0x0
    s_addc_u32 s45, s11, 0
    s_and_b32 s45, s45, 0xffff
    s_mov_b32 s46, 0x6200
    s_mov_b32 s47, 0x00020000
    s_add_u32 s32, s20, 0x200000
    s_addc_u32 s33, s21, 0
    s_and_b32 s33, s33, 0xffff
    s_mov_b32 s34, 0x40000
    s_mov_b32 s35, 0x00020000
    v_lshrrev_b32 v7, 5, v0
    v_and_b32 v8, 31, v0
    v_add_u32 v9, s41, v7
    s_mov_b32 s40, 896
    v_mul_lo_u32 v1, v9, s40
    v_lshl_add_u32 v1, v8, 4, v1
    s_mov_b32 s40, 464
    v_mul_lo_u32 v2, v7, s40
    v_lshl_add_u32 v2, v8, 4, v2
    v_cmp_gt_u32 s[42:43], 28, v8
    v_lshrrev_b32 v7, 4, v0
    v_and_b32 v8, 15, v0
    s_mov_b32 s40, 272
    v_mul_lo_u32 v4, v7, s40
    v_mul_u32_u24 v3, 56, v7
    v_lshl_add_u32 v3, v8, 2, v3
    v_lshl_add_u32 v4, v8, 2, v4
    v_cmp_gt_u32 s[48:49], 14, v8
    v_add_u32 v4, 59392, v4
    s_mov_b32 s40, 0
    buffer_load_dwordx4 v[16:19], v1, s[24:27], s40 offen
    s_mov_b32 s40, 7168
    buffer_load_dwordx4 v[20:23], v1, s[24:27], s40 offen
    s_mov_b32 s40, 14336
    buffer_load_dwordx4 v[24:27], v1, s[24:27], s40 offen
    s_mov_b32 s40, 21504
    buffer_load_dwordx4 v[28:31], v1, s[24:27], s40 offen
    s_mov_b32 s40, 28672
    buffer_load_dwordx4 v[32:35], v1, s[24:27], s40 offen
    s_mov_b32 s40, 35840
    buffer_load_dwordx4 v[36:39], v1, s[24:27], s40 offen
    s_mov_b32 s40, 43008
    buffer_load_dwordx4 v[40:43], v1, s[24:27], s40 offen
    s_mov_b32 s40, 50176
    buffer_load_dwordx4 v[44:47], v1, s[24:27], s40 offen
    s_mov_b32 s40, 57344
    buffer_load_dwordx4 v[48:51], v1, s[24:27], s40 offen
    s_mov_b32 s40, 64512
    buffer_load_dwordx4 v[52:55], v1, s[24:27], s40 offen
    s_mov_b32 s40, 71680
    buffer_load_dwordx4 v[56:59], v1, s[24:27], s40 offen
    s_mov_b32 s40, 78848
    buffer_load_dwordx4 v[60:63], v1, s[24:27], s40 offen
    s_mov_b32 s40, 86016
    buffer_load_dwordx4 v[64:67], v1, s[24:27], s40 offen
    s_mov_b32 s40, 93184
    buffer_load_dwordx4 v[68:71], v1, s[24:27], s40 offen
    s_mov_b32 s40, 100352
    buffer_load_dwordx4 v[72:75], v1, s[24:27], s40 offen
    s_mov_b32 s40, 107520
    buffer_load_dwordx4 v[76:79], v1, s[24:27], s40 offen
    s_mov_b32 s40, 0
    buffer_load_dword v80, v3, s[28:31], s40 offen
    buffer_load_dword v81, v3, s[44:47], s40 offen
    s_mov_b32 s40, 896
    buffer_load_dword v82, v3, s[28:31], s40 offen
    buffer_load_dword v83, v3, s[44:47], s40 offen
    s_mov_b32 s40, 1792
    buffer_load_dword v84, v3, s[28:31], s40 offen
    buffer_load_dword v85, v3, s[44:47], s40 offen
    s_mov_b32 s40, 2688
    buffer_load_dword v86, v3, s[28:31], s40 offen
    buffer_load_dword v87, v3, s[44:47], s40 offen
    s_mov_b32 s40, 3584
    buffer_load_dword v88, v3, s[28:31], s40 offen
    buffer_load_dword v89, v3, s[44:47], s40 offen
    s_mov_b32 s40, 4480
    buffer_load_dword v90, v3, s[28:31], s40 offen
    buffer_load_dword v91, v3, s[44:47], s40 offen
    s_mov_b32 s40, 5376
    buffer_load_dword v92, v3, s[28:31], s40 offen
    buffer_load_dword v93, v3, s[44:47], s40 offen
    s_mov_b32 s40, 6272
    buffer_load_dword v94, v3, s[28:31], s40 offen
    buffer_load_dword v95, v3, s[44:47], s40 offen
    s_mov_b32 s40, 7168
    buffer_load_dword v96, v3, s[28:31], s40 offen
    buffer_load_dword v97, v3, s[44:47], s40 offen
    s_mov_b32 s40, 8064
    buffer_load_dword v98, v3, s[28:31], s40 offen
    buffer_load_dword v99, v3, s[44:47], s40 offen
    s_mov_b32 s40, 8960
    buffer_load_dword v100, v3, s[28:31], s40 offen
    buffer_load_dword v101, v3, s[44:47], s40 offen
    s_mov_b32 s40, 9856
    buffer_load_dword v102, v3, s[28:31], s40 offen
    buffer_load_dword v103, v3, s[44:47], s40 offen
    s_mov_b32 s40, 10752
    buffer_load_dword v104, v3, s[28:31], s40 offen
    buffer_load_dword v105, v3, s[44:47], s40 offen
    s_mov_b32 s40, 11648
    buffer_load_dword v106, v3, s[28:31], s40 offen
    buffer_load_dword v107, v3, s[44:47], s40 offen
    v_lshrrev_b32 v7, 6, v0
    v_and_b32 v8, 63, v0
    v_and_b32 v9, 31, v8
    v_lshrrev_b32 v10, 5, v8
    v_lshl_add_u32 v13, v7, 5, v9
    v_mov_b32 v12, 0
    s_mov_b32 s40, 464
    v_mul_lo_u32 v5, v13, s40
    v_lshl_add_u32 v5, v10, 4, v5
    v_bfe_u32 v14, v8, 2, 2
    v_lshl_add_u32 v14, v10, 3, v14
    s_mov_b32 s40, 272
    v_mul_lo_u32 v6, v14, s40
    v_bfe_u32 v14, v8, 4, 1
    v_lshlrev_b32 v14, 5, v14
    v_lshl_add_u32 v14, v12, 7, v14
    v_and_b32 v15, 3, v8
    v_lshl_add_u32 v14, v15, 3, v14
    v_add_u32 v6, v6, v14
    v_add_u32 v6, 59392, v6
    v_mov_b32 v136, 0
    v_mov_b32 v137, 0
    v_mov_b32 v138, 0
    v_mov_b32 v139, 0
    v_mov_b32 v140, 0
    v_mov_b32 v141, 0
    v_mov_b32 v142, 0
    v_mov_b32 v143, 0
    v_mov_b32 v144, 0
    v_mov_b32 v145, 0
    v_mov_b32 v146, 0
    v_mov_b32 v147, 0
    v_mov_b32 v148, 0
    v_mov_b32 v149, 0
    v_mov_b32 v150, 0
    v_mov_b32 v151, 0
    v_mov_b32 v152, 0
    v_mov_b32 v153, 0
    v_mov_b32 v154, 0
    v_mov_b32 v155, 0
    v_mov_b32 v156, 0
    v_mov_b32 v157, 0
    v_mov_b32 v158, 0
    v_mov_b32 v159, 0
    v_mov_b32 v160, 0
    v_mov_b32 v161, 0
    v_mov_b32 v162, 0
    v_mov_b32 v163, 0
    v_mov_b32 v164, 0
    v_mov_b32 v165, 0
    v_mov_b32 v166, 0
    v_mov_b32 v167, 0
    v_mov_b32 v168, 0
    v_mov_b32 v169, 0
    v_mov_b32 v170, 0
    v_mov_b32 v171, 0
    v_mov_b32 v172, 0
    v_mov_b32 v173, 0
    v_mov_b32 v174, 0
    v_mov_b32 v175, 0
    v_mov_b32 v176, 0
    v_mov_b32 v177, 0
    v_mov_b32 v178, 0
    v_mov_b32 v179, 0
    v_mov_b32 v180, 0
    v_mov_b32 v181, 0
    v_mov_b32 v182, 0
    v_mov_b32 v183, 0
    v_mov_b32 v184, 0
    v_mov_b32 v185, 0
    v_mov_b32 v186, 0
    v_mov_b32 v187, 0
    v_mov_b32 v188, 0
    v_mov_b32 v189, 0
    v_mov_b32 v190, 0
    v_mov_b32 v191, 0
    v_mov_b32 v192, 0
    v_mov_b32 v193, 0
    v_mov_b32 v194, 0
    v_mov_b32 v195, 0
    v_mov_b32 v196, 0
    v_mov_b32 v197, 0
    v_mov_b32 v198, 0
    v_mov_b32 v199, 0
    s_waitcnt vmcnt(0)
    s_mov_b64 exec, s[42:43]
    ds_write_b128 v2, v[16:19] offset:0
    ds_write_b128 v2, v[20:23] offset:3712
    ds_write_b128 v2, v[24:27] offset:7424
    ds_write_b128 v2, v[28:31] offset:11136
    ds_write_b128 v2, v[32:35] offset:14848
    ds_write_b128 v2, v[36:39] offset:18560
    ds_write_b128 v2, v[40:43] offset:22272
    ds_write_b128 v2, v[44:47] offset:25984
    ds_write_b128 v2, v[48:51] offset:29696
    ds_write_b128 v2, v[52:55] offset:33408
    ds_write_b128 v2, v[56:59] offset:37120
    ds_write_b128 v2, v[60:63] offset:40832
    ds_write_b128 v2, v[64:67] offset:44544
    ds_write_b128 v2, v[68:71] offset:48256
    ds_write_b128 v2, v[72:75] offset:51968
    ds_write_b128 v2, v[76:79] offset:55680
    s_mov_b64 exec, -1
    v_cndmask_b32 v80, 0, v80, s[48:49]
    v_cndmask_b32 v81, 0, v81, s[48:49]
    ds_write_b32 v4, v80 offset:0
    ds_write_b32 v4, v81 offset:64
    v_cndmask_b32 v82, 0, v82, s[48:49]
    v_cndmask_b32 v83, 0, v83, s[48:49]
    ds_write_b32 v4, v82 offset:4352
    ds_write_b32 v4, v83 offset:4416
    v_cndmask_b32 v84, 0, v84, s[48:49]
    v_cndmask_b32 v85, 0, v85, s[48:49]
    ds_write_b32 v4, v84 offset:8704
    ds_write_b32 v4, v85 offset:8768
    v_cndmask_b32 v86, 0, v86, s[48:49]
    v_cndmask_b32 v87, 0, v87, s[48:49]
    ds_write_b32 v4, v86 offset:13056
    ds_write_b32 v4, v87 offset:13120
    v_cndmask_b32 v88, 0, v88, s[48:49]
    v_cndmask_b32 v89, 0, v89, s[48:49]
    ds_write_b32 v4, v88 offset:17408
    ds_write_b32 v4, v89 offset:17472
    v_cndmask_b32 v90, 0, v90, s[48:49]
    v_cndmask_b32 v91, 0, v91, s[48:49]
    ds_write_b32 v4, v90 offset:21760
    ds_write_b32 v4, v91 offset:21824
    v_cndmask_b32 v92, 0, v92, s[48:49]
    v_cndmask_b32 v93, 0, v93, s[48:49]
    ds_write_b32 v4, v92 offset:26112
    ds_write_b32 v4, v93 offset:26176
    v_cndmask_b32 v94, 0, v94, s[48:49]
    v_cndmask_b32 v95, 0, v95, s[48:49]
    ds_write_b32 v4, v94 offset:30464
    ds_write_b32 v4, v95 offset:30528
    v_cndmask_b32 v96, 0, v96, s[48:49]
    v_cndmask_b32 v97, 0, v97, s[48:49]
    ds_write_b32 v4, v96 offset:34816
    ds_write_b32 v4, v97 offset:34880
    v_cndmask_b32 v98, 0, v98, s[48:49]
    v_cndmask_b32 v99, 0, v99, s[48:49]
    ds_write_b32 v4, v98 offset:39168
    ds_write_b32 v4, v99 offset:39232
    v_cndmask_b32 v100, 0, v100, s[48:49]
    v_cndmask_b32 v101, 0, v101, s[48:49]
    ds_write_b32 v4, v100 offset:43520
    ds_write_b32 v4, v101 offset:43584
    v_cndmask_b32 v102, 0, v102, s[48:49]
    v_cndmask_b32 v103, 0, v103, s[48:49]
    ds_write_b32 v4, v102 offset:47872
    ds_write_b32 v4, v103 offset:47936
    v_cndmask_b32 v104, 0, v104, s[48:49]
    v_cndmask_b32 v105, 0, v105, s[48:49]
    ds_write_b32 v4, v104 offset:52224
    ds_write_b32 v4, v105 offset:52288
    v_cndmask_b32 v106, 0, v106, s[48:49]
    v_cndmask_b32 v107, 0, v107, s[48:49]
    ds_write_b32 v4, v106 offset:56576
    ds_write_b32 v4, v107 offset:56640
    s_waitcnt lgkmcnt(0)
    s_barrier
    s_mov_b32 s40, 448
    buffer_load_dwordx4 v[16:19], v1, s[24:27], s40 offen
    s_mov_b32 s40, 7616
    buffer_load_dwordx4 v[20:23], v1, s[24:27], s40 offen
    s_mov_b32 s40, 14784
    buffer_load_dwordx4 v[24:27], v1, s[24:27], s40 offen
    s_mov_b32 s40, 21952
    buffer_load_dwordx4 v[28:31], v1, s[24:27], s40 offen
    s_mov_b32 s40, 29120
    buffer_load_dwordx4 v[32:35], v1, s[24:27], s40 offen
    s_mov_b32 s40, 36288
    buffer_load_dwordx4 v[36:39], v1, s[24:27], s40 offen
    s_mov_b32 s40, 43456
    buffer_load_dwordx4 v[40:43], v1, s[24:27], s40 offen
    s_mov_b32 s40, 50624
    buffer_load_dwordx4 v[44:47], v1, s[24:27], s40 offen
    s_mov_b32 s40, 57792
    buffer_load_dwordx4 v[48:51], v1, s[24:27], s40 offen
    s_mov_b32 s40, 64960
    buffer_load_dwordx4 v[52:55], v1, s[24:27], s40 offen
    s_mov_b32 s40, 72128
    buffer_load_dwordx4 v[56:59], v1, s[24:27], s40 offen
    s_mov_b32 s40, 79296
    buffer_load_dwordx4 v[60:63], v1, s[24:27], s40 offen
    s_mov_b32 s40, 86464
    buffer_load_dwordx4 v[64:67], v1, s[24:27], s40 offen
    s_mov_b32 s40, 93632
    buffer_load_dwordx4 v[68:71], v1, s[24:27], s40 offen
    s_mov_b32 s40, 100800
    buffer_load_dwordx4 v[72:75], v1, s[24:27], s40 offen
    s_mov_b32 s40, 107968
    buffer_load_dwordx4 v[76:79], v1, s[24:27], s40 offen
    s_mov_b32 s40, 12544
    buffer_load_dword v80, v3, s[28:31], s40 offen
    buffer_load_dword v81, v3, s[44:47], s40 offen
    s_mov_b32 s40, 13440
    buffer_load_dword v82, v3, s[28:31], s40 offen
    buffer_load_dword v83, v3, s[44:47], s40 offen
    s_mov_b32 s40, 14336
    buffer_load_dword v84, v3, s[28:31], s40 offen
    buffer_load_dword v85, v3, s[44:47], s40 offen
    s_mov_b32 s40, 15232
    buffer_load_dword v86, v3, s[28:31], s40 offen
    buffer_load_dword v87, v3, s[44:47], s40 offen
    s_mov_b32 s40, 16128
    buffer_load_dword v88, v3, s[28:31], s40 offen
    buffer_load_dword v89, v3, s[44:47], s40 offen
    s_mov_b32 s40, 17024
    buffer_load_dword v90, v3, s[28:31], s40 offen
    buffer_load_dword v91, v3, s[44:47], s40 offen
    s_mov_b32 s40, 17920
    buffer_load_dword v92, v3, s[28:31], s40 offen
    buffer_load_dword v93, v3, s[44:47], s40 offen
    s_mov_b32 s40, 18816
    buffer_load_dword v94, v3, s[28:31], s40 offen
    buffer_load_dword v95, v3, s[44:47], s40 offen
    s_mov_b32 s40, 19712
    buffer_load_dword v96, v3, s[28:31], s40 offen
    buffer_load_dword v97, v3, s[44:47], s40 offen
    s_mov_b32 s40, 20608
    buffer_load_dword v98, v3, s[28:31], s40 offen
    buffer_load_dword v99, v3, s[44:47], s40 offen
    s_mov_b32 s40, 21504
    buffer_load_dword v100, v3, s[28:31], s40 offen
    buffer_load_dword v101, v3, s[44:47], s40 offen
    s_mov_b32 s40, 22400
    buffer_load_dword v102, v3, s[28:31], s40 offen
    buffer_load_dword v103, v3, s[44:47], s40 offen
    s_mov_b32 s40, 23296
    buffer_load_dword v104, v3, s[28:31], s40 offen
    buffer_load_dword v105, v3, s[44:47], s40 offen
    s_mov_b32 s40, 24192
    buffer_load_dword v106, v3, s[28:31], s40 offen
    buffer_load_dword v107, v3, s[44:47], s40 offen
    v_mov_b32 v232, v5
    v_mov_b32 v233, v6
    s_mov_b32 s50, 0
    ds_read_b128 v[200:203], v232 offset:0
    ds_read_b64_tr_b16 v[208:209], v233 offset:0
    ds_read_b64_tr_b16 v[210:211], v233 offset:1088
    ds_read_b64_tr_b16 v[212:213], v233 offset:64
    ds_read_b64_tr_b16 v[214:215], v233 offset:1152
gk3:
    ds_read_b128 v[216:219], v232 offset:32
    ds_read_b64_tr_b16 v[224:225], v233 offset:4352
    ds_read_b64_tr_b16 v[226:227], v233 offset:5440
    ds_read_b64_tr_b16 v[228:229], v233 offset:4416
    ds_read_b64_tr_b16 v[230:231], v233 offset:5504
    s_waitcnt lgkmcnt(5)
    v_mfma_f32_32x32x16_bf16 v[136:151], v[208:211], v[200:203], v[136:151]
    v_mfma_f32_32x32x16_bf16 v[152:167], v[200:203], v[212:215], v[152:167]
    ds_read_b128 v[200:203], v232 offset:64
    ds_read_b64_tr_b16 v[208:209], v233 offset:8704
    ds_read_b64_tr_b16 v[210:211], v233 offset:9792
    ds_read_b64_tr_b16 v[212:213], v233 offset:8768
    ds_read_b64_tr_b16 v[214:215], v233 offset:9856
    s_waitcnt lgkmcnt(5)
    v_mfma_f32_32x32x16_bf16 v[136:151], v[224:227], v[216:219], v[136:151]
    v_mfma_f32_32x32x16_bf16 v[152:167], v[216:219], v[228:231], v[152:167]
    v_add_u32 v232, 64, v232
    v_add_u32 v233, 8704, v233
    s_add_u32 s50, s50, 1
    s_cmp_lt_u32 s50, 7
    s_cbranch_scc1 gk3
    s_waitcnt lgkmcnt(0)
    s_barrier
    s_waitcnt vmcnt(0)
    s_mov_b64 exec, s[42:43]
    ds_write_b128 v2, v[16:19] offset:0
    ds_write_b128 v2, v[20:23] offset:3712
    ds_write_b128 v2, v[24:27] offset:7424
    ds_write_b128 v2, v[28:31] offset:11136
    ds_write_b128 v2, v[32:35] offset:14848
    ds_write_b128 v2, v[36:39] offset:18560
    ds_write_b128 v2, v[40:43] offset:22272
    ds_write_b128 v2, v[44:47] offset:25984
    ds_write_b128 v2, v[48:51] offset:29696
    ds_write_b128 v2, v[52:55] offset:33408
    ds_write_b128 v2, v[56:59] offset:37120
    ds_write_b128 v2, v[60:63] offset:40832
    ds_write_b128 v2, v[64:67] offset:44544
    ds_write_b128 v2, v[68:71] offset:48256
    ds_write_b128 v2, v[72:75] offset:51968
    ds_write_b128 v2, v[76:79] offset:55680
    s_mov_b64 exec, -1
    v_cndmask_b32 v80, 0, v80, s[48:49]
    v_cndmask_b32 v81, 0, v81, s[48:49]
    ds_write_b32 v4, v80 offset:0
    ds_write_b32 v4, v81 offset:64
    v_cndmask_b32 v82, 0, v82, s[48:49]
    v_cndmask_b32 v83, 0, v83, s[48:49]
    ds_write_b32 v4, v82 offset:4352
    ds_write_b32 v4, v83 offset:4416
    v_cndmask_b32 v84, 0, v84, s[48:49]
    v_cndmask_b32 v85, 0, v85, s[48:49]
    ds_write_b32 v4, v84 offset:8704
    ds_write_b32 v4, v85 offset:8768
    v_cndmask_b32 v86, 0, v86, s[48:49]
    v_cndmask_b32 v87, 0, v87, s[48:49]
    ds_write_b32 v4, v86 offset:13056
    ds_write_b32 v4, v87 offset:13120
    v_cndmask_b32 v88, 0, v88, s[48:49]
    v_cndmask_b32 v89, 0, v89, s[48:49]
    ds_write_b32 v4, v88 offset:17408
    ds_write_b32 v4, v89 offset:17472
    v_cndmask_b32 v90, 0, v90, s[48:49]
    v_cndmask_b32 v91, 0, v91, s[48:49]
    ds_write_b32 v4, v90 offset:21760
    ds_write_b32 v4, v91 offset:21824
    v_cndmask_b32 v92, 0, v92, s[48:49]
    v_cndmask_b32 v93, 0, v93, s[48:49]
    ds_write_b32 v4, v92 offset:26112
    ds_write_b32 v4, v93 offset:26176
    v_cndmask_b32 v94, 0, v94, s[48:49]
    v_cndmask_b32 v95, 0, v95, s[48:49]
    ds_write_b32 v4, v94 offset:30464
    ds_write_b32 v4, v95 offset:30528
    v_cndmask_b32 v96, 0, v96, s[48:49]
    v_cndmask_b32 v97, 0, v97, s[48:49]
    ds_write_b32 v4, v96 offset:34816
    ds_write_b32 v4, v97 offset:34880
    v_cndmask_b32 v98, 0, v98, s[48:49]
    v_cndmask_b32 v99, 0, v99, s[48:49]
    ds_write_b32 v4, v98 offset:39168
    ds_write_b32 v4, v99 offset:39232
    v_cndmask_b32 v100, 0, v100, s[48:49]
    v_cndmask_b32 v101, 0, v101, s[48:49]
    ds_write_b32 v4, v100 offset:43520
    ds_write_b32 v4, v101 offset:43584
    v_cndmask_b32 v102, 0, v102, s[48:49]
    v_cndmask_b32 v103, 0, v103, s[48:49]
    ds_write_b32 v4, v102 offset:47872
    ds_write_b32 v4, v103 offset:47936
    v_cndmask_b32 v104, 0, v104, s[48:49]
    v_cndmask_b32 v105, 0, v105, s[48:49]
    ds_write_b32 v4, v104 offset:52224
    ds_write_b32 v4, v105 offset:52288
    v_cndmask_b32 v106, 0, v106, s[48:49]
    v_cndmask_b32 v107, 0, v107, s[48:49]
    ds_write_b32 v4, v106 offset:56576
    ds_write_b32 v4, v107 offset:56640
    s_waitcnt lgkmcnt(0)
    s_barrier
    v_mov_b32 v232, v5
    v_mov_b32 v233, v6
    s_mov_b32 s50, 0
    ds_read_b128 v[200:203], v232 offset:0
    ds_read_b64_tr_b16 v[208:209], v233 offset:0
    ds_read_b64_tr_b16 v[210:211], v233 offset:1088
    ds_read_b64_tr_b16 v[212:213], v233 offset:64
    ds_read_b64_tr_b16 v[214:215], v233 offset:1152
gk4:
    ds_read_b128 v[216:219], v232 offset:32
    ds_read_b64_tr_b16 v[224:225], v233 offset:4352
    ds_read_b64_tr_b16 v[226:227], v233 offset:5440
    ds_read_b64_tr_b16 v[228:229], v233 offset:4416
    ds_read_b64_tr_b16 v[230:231], v233 offset:5504
    s_waitcnt lgkmcnt(5)
    v_mfma_f32_32x32x16_bf16 v[136:151], v[208:211], v[200:203], v[136:151]
    v_mfma_f32_32x32x16_bf16 v[152:167], v[200:203], v[212:215], v[152:167]
    ds_read_b128 v[200:203], v232 offset:64
    ds_read_b64_tr_b16 v[208:209], v233 offset:8704
    ds_read_b64_tr_b16 v[210:211], v233 offset:9792
    ds_read_b64_tr_b16 v[212:213], v233 offset:8768
    ds_read_b64_tr_b16 v[214:215], v233 offset:9856
    s_waitcnt lgkmcnt(5)
    v_mfma_f32_32x32x16_bf16 v[136:151], v[224:227], v[216:219], v[136:151]
    v_mfma_f32_32x32x16_bf16 v[152:167], v[216:219], v[228:231], v[152:167]
    v_add_u32 v232, 64, v232
    v_add_u32 v233, 8704, v233
    s_add_u32 s50, s50, 1
    s_cmp_lt_u32 s50, 7
    s_cbranch_scc1 gk4
    s_waitcnt lgkmcnt(0)
    s_nop 15
    s_nop 3
    v_add_u32 v16, s41, v13
    v_lshlrev_b32 v16, 4, v16
    v_lshl_add_u32 v16, v10, 3, v16
    v_cvt_pk_bf16_f32 v20, v136, v137
    v_cvt_pk_bf16_f32 v21, v138, v139
    s_mov_b32 s40, 0
    buffer_store_dwordx2 v[20:21], v16, s[32:35], s40 offen
    s_nop 1
    v_cvt_pk_bf16_f32 v20, v140, v141
    v_cvt_pk_bf16_f32 v21, v142, v143
    s_mov_b32 s40, 32768
    buffer_store_dwordx2 v[20:21], v16, s[32:35], s40 offen
    s_nop 1
    v_cvt_pk_bf16_f32 v20, v144, v145
    v_cvt_pk_bf16_f32 v21, v146, v147
    s_mov_b32 s40, 65536
    buffer_store_dwordx2 v[20:21], v16, s[32:35], s40 offen
    s_nop 1
    v_cvt_pk_bf16_f32 v20, v148, v149
    v_cvt_pk_bf16_f32 v21, v150, v151
    s_mov_b32 s40, 98304
    buffer_store_dwordx2 v[20:21], v16, s[32:35], s40 offen
    s_nop 1
    v_lshlrev_b32 v16, 5, v7
    v_add_u32 v16, s41, v16
    v_lshlrev_b32 v16, 6, v16
    v_lshl_add_u32 v16, v10, 9, v16
    v_lshl_add_u32 v16, v9, 4, v16
    v_cmp_eq_u32 vcc, 28, v9
    v_cmp_lt_u32 s[48:49], 28, v9
    s_mov_b32 s40, 0x3f803f80
    v_mov_b32 v22, s40
    s_nop 1
    v_cvt_pk_bf16_f32 v20, v152, v153
    v_cvt_pk_bf16_f32 v21, v154, v155
    v_cndmask_b32 v20, v20, v22, vcc
    v_cndmask_b32 v21, v21, v22, vcc
    v_cndmask_b32 v20, v20, 0, s[48:49]
    v_cndmask_b32 v21, v21, 0, s[48:49]
    s_mov_b32 s40, 131072
    buffer_store_dwordx2 v[20:21], v16, s[32:35], s40 offen
    s_nop 1
    v_cvt_pk_bf16_f32 v20, v156, v157
    v_cvt_pk_bf16_f32 v21, v158, v159
    v_cndmask_b32 v20, v20, v22, vcc
    v_cndmask_b32 v21, v21, v22, vcc
    v_cndmask_b32 v20, v20, 0, s[48:49]
    v_cndmask_b32 v21, v21, 0, s[48:49]
    s_mov_b32 s40, 131080
    buffer_store_dwordx2 v[20:21], v16, s[32:35], s40 offen
    s_nop 1
    v_cvt_pk_bf16_f32 v20, v160, v161
    v_cvt_pk_bf16_f32 v21, v162, v163
    v_cndmask_b32 v20, v20, v22, vcc
    v_cndmask_b32 v21, v21, v22, vcc
    v_cndmask_b32 v20, v20, 0, s[48:49]
    v_cndmask_b32 v21, v21, 0, s[48:49]
    s_mov_b32 s40, 132096
    buffer_store_dwordx2 v[20:21], v16, s[32:35], s40 offen
    s_nop 1
    v_cvt_pk_bf16_f32 v20, v164, v165
    v_cvt_pk_bf16_f32 v21, v166, v167
    v_cndmask_b32 v20, v20, v22, vcc
    v_cndmask_b32 v21, v21, v22, vcc
    v_cndmask_b32 v20, v20, 0, s[48:49]
    v_cndmask_b32 v21, v21, 0, s[48:49]
    s_mov_b32 s40, 132104
    buffer_store_dwordx2 v[20:21], v16, s[32:35], s40 offen
    s_nop 1
    s_endpgm
k1_exit:
    s_endpgm
.section .rodata,"a"
.p2align 6
.amdhsa_kernel k1_proj_kernel
  .amdhsa_next_free_vgpr 256
  .amdhsa_next_free_sgpr 96
  .amdhsa_accum_offset 256
  .amdhsa_group_segment_fixed_size 0
  .amdhsa_kernarg_size 88
  .amdhsa_user_sgpr_count 2
  .amdhsa_user_sgpr_kernarg_segment_ptr 1
  .amdhsa_system_sgpr_workgroup_id_x 1
.end_amdhsa_kernel
.text
.globl k2_attn_kernel
.p2align 8
.type k2_attn_kernel,@function
k2_attn_kernel:
    s_cmp_ge_u32 s2, 256
    s_cbranch_scc1 k2_exit
    s_load_dwordx2 s[20:21], s[0:1], 80
    s_waitcnt lgkmcnt(0)
    s_add_u32 s24, s20, 0x0
    s_addc_u32 s25, s21, 0
    s_and_b32 s25, s25, 0xffff
    s_mov_b32 s26, 0x1c0000
    s_mov_b32 s27, 0x00020000
    s_add_u32 s28, s20, 0x200000
    s_addc_u32 s29, s21, 0
    s_and_b32 s29, s29, 0xffff
    s_mov_b32 s30, 0x40000
    s_mov_b32 s31, 0x00020000
    s_add_u32 s32, s20, 0x900000
    s_addc_u32 s33, s21, 0
    s_and_b32 s33, s33, 0xffff
    s_mov_b32 s34, 0x1c0000
    s_mov_b32 s35, 0x00020000
    v_and_b32 v1, 63, v0
    v_lshrrev_b32 v2, 6, v0
    v_and_b32 v3, 31, v1
    v_lshrrev_b32 v4, 5, v1
    v_and_b32 v5, 3, v2
    v_lshrrev_b32 v6, 2, v2
    s_nop 0
    v_readfirstlane_b32 s36, v6
    s_cmp_ge_u32 s36, 2
    s_cbranch_scc1 k2_b
    v_lshrrev_b32 v7, 8, v0
    v_and_b32 v9, 255, v0
    v_lshlrev_b32 v88, 15, v7
    v_lshl_add_u32 v88, v9, 4, v88
    v_lshlrev_b32 v89, 12, v7
    v_lshl_add_u32 v89, v9, 4, v89
    v_lshlrev_b32 v90, 4, v0
    v_add_u32 v132, 65536, v89
    v_add_u32 v133, 65536, v90
    s_mov_b32 s40, 0
    buffer_load_dwordx4 v[100:103], v88, s[28:31], s40 offen
    s_mov_b32 s40, 65536
    buffer_load_dwordx4 v[104:107], v88, s[28:31], s40 offen
    s_mov_b32 s40, 16384
    buffer_load_dwordx4 v[108:111], v88, s[28:31], s40 offen
    s_mov_b32 s40, 81920
    buffer_load_dwordx4 v[112:115], v88, s[28:31], s40 offen
    s_mov_b32 s40, 131072
    buffer_load_dwordx4 v[116:119], v90, s[28:31], s40 offen
    s_mov_b32 s40, 139264
    buffer_load_dwordx4 v[120:123], v90, s[28:31], s40 offen
    s_mov_b32 s40, 196608
    buffer_load_dwordx4 v[124:127], v90, s[28:31], s40 offen
    s_mov_b32 s40, 204800
    buffer_load_dwordx4 v[128:131], v90, s[28:31], s40 offen
    s_lshl_b32 s41, s2, 3
    v_lshrrev_b32 v7, 4, v3
    v_lshl_add_u32 v7, v5, 1, v7
    v_add_u32 v7, s41, v7
    s_mov_b32 s40, 896
    v_mul_lo_u32 v7, v7, s40
    v_and_b32 v9, 15, v3
    v_mul_u32_u24 v9, 56, v9
    v_add_u32 v7, v7, v9
    v_lshl_add_u32 v98, v4, 4, v7
    buffer_load_dwordx4 v[8:11], v98, s[24:27], 0 offen
    buffer_load_dwordx4 v[12:15], v98, s[24:27], 0 offen offset:32
    v_cmp_gt_u32 vcc, 32, v1
    s_waitcnt vmcnt(0)
    s_nop 1
    v_cndmask_b32 v14, 0, v14, vcc
    v_cndmask_b32 v15, 0, v15, vcc
    v_mov_b32 v32, 0
    v_mov_b32 v33, 0
    v_mov_b32 v34, 0
    v_mov_b32 v35, 0
    v_mov_b32 v36, 0
    v_mov_b32 v37, 0
    v_mov_b32 v38, 0
    v_mov_b32 v39, 0
    v_mov_b32 v40, 0
    v_mov_b32 v41, 0
    v_mov_b32 v42, 0
    v_mov_b32 v43, 0
    v_mov_b32 v44, 0
    v_mov_b32 v45, 0
    v_mov_b32 v46, 0
    v_mov_b32 v47, 0
    v_mov_b32 v91, 0xff800000
    v_lshlrev_b32 v92, 15, v6
    v_lshl_add_u32 v93, v4, 12, v92
    v_lshl_add_u32 v93, v3, 4, v93
    v_lshl_add_u32 v94, v4, 9, v92
    v_lshl_add_u32 v94, v3, 4, v94
    v_add_u32 v94, 16384, v94
    v_add_u32 v98, 65536, v93
    v_add_u32 v99, 65536, v94
    s_mov_b32 s42, 0x3e8b97f6
    s_waitcnt vmcnt(0)
    ds_write_b128 v89, v[100:103] offset:0
    ds_write_b128 v89, v[104:107] offset:8192
    ds_write_b128 v89, v[108:111] offset:32768
    ds_write_b128 v89, v[112:115] offset:40960
    ds_write_b128 v90, v[116:119] offset:16384
    ds_write_b128 v90, v[120:123] offset:24576
    ds_write_b128 v90, v[124:127] offset:49152
    ds_write_b128 v90, v[128:131] offset:57344
    s_waitcnt lgkmcnt(0)
    s_barrier
    s_mov_b32 s50, 0
    s_mov_b32 s52, 0
    s_mov_b32 s53, 0x20000
k2_stage:
    s_cmp_ge_u32 s50, 3
    s_cbranch_scc1 k2_noload
    s_add_u32 s52, s52, 4096
    s_add_u32 s53, s53, 16384
    s_add_u32 s40, s52, 0
    buffer_load_dwordx4 v[100:103], v88, s[28:31], s40 offen
    s_add_u32 s40, s52, 65536
    buffer_load_dwordx4 v[104:107], v88, s[28:31], s40 offen
    s_add_u32 s40, s52, 16384
    buffer_load_dwordx4 v[108:111], v88, s[28:31], s40 offen
    s_add_u32 s40, s52, 81920
    buffer_load_dwordx4 v[112:115], v88, s[28:31], s40 offen
    s_add_u32 s40, s53, 0
    buffer_load_dwordx4 v[116:119], v90, s[28:31], s40 offen
    s_add_u32 s40, s53, 8192
    buffer_load_dwordx4 v[120:123], v90, s[28:31], s40 offen
    s_add_u32 s40, s53, 65536
    buffer_load_dwordx4 v[124:127], v90, s[28:31], s40 offen
    s_add_u32 s40, s53, 73728
    buffer_load_dwordx4 v[128:131], v90, s[28:31], s40 offen
k2_noload:
    v_mov_b32 v98, v93
    v_mov_b32 v99, v94
    s_mov_b32 s51, 0
    ds_read_b128 v[48:51], v98 offset:0
    ds_read_b128 v[52:55], v98 offset:8192
    s_waitcnt lgkmcnt(0)
    v_mfma_f32_32x32x16_bf16 v[16:31], v[48:51], v[8:11], 0
    v_mfma_f32_32x32x16_bf16 v[16:31], v[52:55], v[12:15], v[16:31]
k2_tile:
    ds_read_b128 v[48:51], v98 offset:512
    ds_read_b128 v[52:55], v98 offset:8704
    ds_read_b128 v[56:59], v99 offset:0
    ds_read_b128 v[60:63], v99 offset:1024
    s_waitcnt lgkmcnt(2)
    v_mfma_f32_32x32x16_bf16 v[72:87], v[48:51], v[8:11], 0
    v_mfma_f32_32x32x16_bf16 v[72:87], v[52:55], v[12:15], v[72:87]
    s_nop 5
    v_max3_f32 v95, v16, v17, v18
    v_max3_f32 v95, v95, v19, v20
    v_max3_f32 v95, v95, v21, v22
    v_max3_f32 v95, v95, v23, v24
    v_max3_f32 v95, v95, v25, v26
    v_max3_f32 v95, v95, v27, v28
    v_max3_f32 v95, v95, v29, v30
    v_max_f32 v95, v95, v31
    v_mov_b32 v96, v95
    s_nop 1
    v_permlane32_swap_b32 v95, v96
    v_max3_f32 v96, v95, v96, v91
    v_cmp_gt_f32 vcc, v96, v91
    v_sub_f32 v97, v91, v96
    v_mul_f32 v97, s42, v97
    v_exp_f32 v97, v97
    v_mov_b32 v91, v96
    v_mul_f32 v96, s42, v96
    v_fma_f32 v16, v16, s42, -v96
    v_fma_f32 v17, v17, s42, -v96
    v_fma_f32 v18, v18, s42, -v96
    v_fma_f32 v19, v19, s42, -v96
    v_fma_f32 v20, v20, s42, -v96
    v_fma_f32 v21, v21, s42, -v96
    v_fma_f32 v22, v22, s42, -v96
    v_fma_f32 v23, v23, s42, -v96
    v_fma_f32 v24, v24, s42, -v96
    v_fma_f32 v25, v25, s42, -v96
    v_fma_f32 v26, v26, s42, -v96
    v_fma_f32 v27, v27, s42, -v96
    v_fma_f32 v28, v28, s42, -v96
    v_fma_f32 v29, v29, s42, -v96
    v_fma_f32 v30, v30, s42, -v96
    v_fma_f32 v31, v31, s42, -v96
    v_exp_f32 v16, v16
    v_exp_f32 v17, v17
    v_exp_f32 v18, v18
    v_exp_f32 v19, v19
    v_exp_f32 v20, v20
    v_exp_f32 v21, v21
    v_exp_f32 v22, v22
    v_exp_f32 v23, v23
    v_exp_f32 v24, v24
    v_exp_f32 v25, v25
    v_exp_f32 v26, v26
    v_exp_f32 v27, v27
    v_exp_f32 v28, v28
    v_exp_f32 v29, v29
    v_exp_f32 v30, v30
    v_exp_f32 v31, v31
    v_cvt_pk_bf16_f32 v64, v16, v17
    v_cvt_pk_bf16_f32 v65, v18, v19
    v_cvt_pk_bf16_f32 v66, v20, v21
    v_cvt_pk_bf16_f32 v67, v22, v23
    v_cvt_pk_bf16_f32 v68, v24, v25
    v_cvt_pk_bf16_f32 v69, v26, v27
    v_cvt_pk_bf16_f32 v70, v28, v29
    v_cvt_pk_bf16_f32 v71, v30, v31
    s_cbranch_vccz k2_sk0
    v_mul_f32 v32, v97, v32
    v_mul_f32 v33, v97, v33
    v_mul_f32 v34, v97, v34
    v_mul_f32 v35, v97, v35
    v_mul_f32 v36, v97, v36
    v_mul_f32 v37, v97, v37
    v_mul_f32 v38, v97, v38
    v_mul_f32 v39, v97, v39
    v_mul_f32 v40, v97, v40
    v_mul_f32 v41, v97, v41
    v_mul_f32 v42, v97, v42
    v_mul_f32 v43, v97, v43
    v_mul_f32 v44, v97, v44
    v_mul_f32 v45, v97, v45
    v_mul_f32 v46, v97, v46
    v_mul_f32 v47, v97, v47
k2_sk0:
    s_waitcnt lgkmcnt(0)
    s_nop 1
    v_mfma_f32_32x32x16_bf16 v[32:47], v[56:59], v[64:67], v[32:47]
    v_mfma_f32_32x32x16_bf16 v[32:47], v[60:63], v[68:71], v[32:47]
    s_nop 7
    ds_read_b128 v[48:51], v98 offset:1024
    ds_read_b128 v[52:55], v98 offset:9216
    ds_read_b128 v[56:59], v99 offset:2048
    ds_read_b128 v[60:63], v99 offset:3072
    s_waitcnt lgkmcnt(2)
    v_mfma_f32_32x32x16_bf16 v[16:31], v[48:51], v[8:11], 0
    v_mfma_f32_32x32x16_bf16 v[16:31], v[52:55], v[12:15], v[16:31]
    s_nop 5
    v_max3_f32 v95, v72, v73, v74
    v_max3_f32 v95, v95, v75, v76
    v_max3_f32 v95, v95, v77, v78
    v_max3_f32 v95, v95, v79, v80
    v_max3_f32 v95, v95, v81, v82
    v_max3_f32 v95, v95, v83, v84
    v_max3_f32 v95, v95, v85, v86
    v_max_f32 v95, v95, v87
    v_mov_b32 v96, v95
    s_nop 1
    v_permlane32_swap_b32 v95, v96
    v_max3_f32 v96, v95, v96, v91
    v_cmp_gt_f32 vcc, v96, v91
    v_sub_f32 v97, v91, v96
    v_mul_f32 v97, s42, v97
    v_exp_f32 v97, v97
    v_mov_b32 v91, v96
    v_mul_f32 v96, s42, v96
    v_fma_f32 v72, v72, s42, -v96
    v_fma_f32 v73, v73, s42, -v96
    v_fma_f32 v74, v74, s42, -v96
    v_fma_f32 v75, v75, s42, -v96
    v_fma_f32 v76, v76, s42, -v96
    v_fma_f32 v77, v77, s42, -v96
    v_fma_f32 v78, v78, s42, -v96
    v_fma_f32 v79, v79, s42, -v96
    v_fma_f32 v80, v80, s42, -v96
    v_fma_f32 v81, v81, s42, -v96
    v_fma_f32 v82, v82, s42, -v96
    v_fma_f32 v83, v83, s42, -v96
    v_fma_f32 v84, v84, s42, -v96
    v_fma_f32 v85, v85, s42, -v96
    v_fma_f32 v86, v86, s42, -v96
    v_fma_f32 v87, v87, s42, -v96
    v_exp_f32 v72, v72
    v_exp_f32 v73, v73
    v_exp_f32 v74, v74
    v_exp_f32 v75, v75
    v_exp_f32 v76, v76
    v_exp_f32 v77, v77
    v_exp_f32 v78, v78
    v_exp_f32 v79, v79
    v_exp_f32 v80, v80
    v_exp_f32 v81, v81
    v_exp_f32 v82, v82
    v_exp_f32 v83, v83
    v_exp_f32 v84, v84
    v_exp_f32 v85, v85
    v_exp_f32 v86, v86
    v_exp_f32 v87, v87
    v_cvt_pk_bf16_f32 v64, v72, v73
    v_cvt_pk_bf16_f32 v65, v74, v75
    v_cvt_pk_bf16_f32 v66, v76, v77
    v_cvt_pk_bf16_f32 v67, v78, v79
    v_cvt_pk_bf16_f32 v68, v80, v81
    v_cvt_pk_bf16_f32 v69, v82, v83
    v_cvt_pk_bf16_f32 v70, v84, v85
    v_cvt_pk_bf16_f32 v71, v86, v87
    s_cbranch_vccz k2_sk1
    v_mul_f32 v32, v97, v32
    v_mul_f32 v33, v97, v33
    v_mul_f32 v34, v97, v34
    v_mul_f32 v35, v97, v35
    v_mul_f32 v36, v97, v36
    v_mul_f32 v37, v97, v37
    v_mul_f32 v38, v97, v38
    v_mul_f32 v39, v97, v39
    v_mul_f32 v40, v97, v40
    v_mul_f32 v41, v97, v41
    v_mul_f32 v42, v97, v42
    v_mul_f32 v43, v97, v43
    v_mul_f32 v44, v97, v44
    v_mul_f32 v45, v97, v45
    v_mul_f32 v46, v97, v46
    v_mul_f32 v47, v97, v47
k2_sk1:
    s_waitcnt lgkmcnt(0)
    s_nop 1
    v_mfma_f32_32x32x16_bf16 v[32:47], v[56:59], v[64:67], v[32:47]
    v_mfma_f32_32x32x16_bf16 v[32:47], v[60:63], v[68:71], v[32:47]
    s_nop 7
    v_add_u32 v98, 1024, v98
    v_add_u32 v99, 4096, v99
    s_add_u32 s51, s51, 1
    s_cmp_lt_u32 s51, 4
    s_cbranch_scc1 k2_tile
    s_add_u32 s50, s50, 1
    s_cmp_ge_u32 s50, 4
    s_cbranch_scc1 k2_done
    v_xor_b32 v93, 0x10000, v93
    v_xor_b32 v94, 0x10000, v94
    s_waitcnt vmcnt(0)
    ds_write_b128 v132, v[100:103] offset:0
    ds_write_b128 v132, v[104:107] offset:8192
    ds_write_b128 v132, v[108:111] offset:32768
    ds_write_b128 v132, v[112:115] offset:40960
    ds_write_b128 v133, v[116:119] offset:16384
    ds_write_b128 v133, v[120:123] offset:24576
    ds_write_b128 v133, v[124:127] offset:49152
    ds_write_b128 v133, v[128:131] offset:57344
    v_xor_b32 v132, 0x10000, v132
    v_xor_b32 v133, 0x10000, v133
    s_waitcnt lgkmcnt(0)
    s_barrier
    s_branch k2_stage
k2_done:
    s_nop 15
    s_barrier
    v_mul_u32_u24 v92, 4352, v5
    v_lshl_add_u32 v92, v1, 2, v92
    s_cmp_eq_u32 s36, 0
    s_cbranch_scc1 k2_low
    ds_write_b32 v92, v32 offset:0
    ds_write_b32 v92, v33 offset:256
    ds_write_b32 v92, v34 offset:512
    ds_write_b32 v92, v35 offset:768
    ds_write_b32 v92, v36 offset:1024
    ds_write_b32 v92, v37 offset:1280
    ds_write_b32 v92, v38 offset:1536
    ds_write_b32 v92, v39 offset:1792
    ds_write_b32 v92, v40 offset:2048
    ds_write_b32 v92, v41 offset:2304
    ds_write_b32 v92, v42 offset:2560
    ds_write_b32 v92, v43 offset:2816
    ds_write_b32 v92, v44 offset:3072
    ds_write_b32 v92, v45 offset:3328
    ds_write_b32 v92, v46 offset:3584
    ds_write_b32 v92, v47 offset:3840
    ds_write_b32 v92, v91 offset:4096
    s_waitcnt lgkmcnt(0)
    s_barrier
    s_endpgm
k2_low:
    s_barrier
    ds_read_b32 v48, v92 offset:0
    ds_read_b32 v49, v92 offset:256
    ds_read_b32 v50, v92 offset:512
    ds_read_b32 v51, v92 offset:768
    ds_read_b32 v52, v92 offset:1024
    ds_read_b32 v53, v92 offset:1280
    ds_read_b32 v54, v92 offset:1536
    ds_read_b32 v55, v92 offset:1792
    ds_read_b32 v56, v92 offset:2048
    ds_read_b32 v57, v92 offset:2304
    ds_read_b32 v58, v92 offset:2560
    ds_read_b32 v59, v92 offset:2816
    ds_read_b32 v60, v92 offset:3072
    ds_read_b32 v61, v92 offset:3328
    ds_read_b32 v62, v92 offset:3584
    ds_read_b32 v63, v92 offset:3840
    ds_read_b32 v95, v92 offset:4096
    s_waitcnt lgkmcnt(0)
    v_max_f32 v96, v95, v91
    v_sub_f32 v97, v91, v96
    v_sub_f32 v95, v95, v96
    v_mul_f32 v97, s42, v97
    v_mul_f32 v95, s42, v95
    v_exp_f32 v97, v97
    v_exp_f32 v95, v95
    s_nop 0
    v_mul_f32 v32, v97, v32
    v_fma_f32 v32, v95, v48, v32
    v_mul_f32 v33, v97, v33
    v_fma_f32 v33, v95, v49, v33
    v_mul_f32 v34, v97, v34
    v_fma_f32 v34, v95, v50, v34
    v_mul_f32 v35, v97, v35
    v_fma_f32 v35, v95, v51, v35
    v_mul_f32 v36, v97, v36
    v_fma_f32 v36, v95, v52, v36
    v_mul_f32 v37, v97, v37
    v_fma_f32 v37, v95, v53, v37
    v_mul_f32 v38, v97, v38
    v_fma_f32 v38, v95, v54, v38
    v_mul_f32 v39, v97, v39
    v_fma_f32 v39, v95, v55, v39
    v_mul_f32 v40, v97, v40
    v_fma_f32 v40, v95, v56, v40
    v_mul_f32 v41, v97, v41
    v_fma_f32 v41, v95, v57, v41
    v_mul_f32 v42, v97, v42
    v_fma_f32 v42, v95, v58, v42
    v_mul_f32 v43, v97, v43
    v_fma_f32 v43, v95, v59, v43
    v_mul_f32 v44, v97, v44
    v_fma_f32 v44, v95, v60, v44
    v_mul_f32 v45, v97, v45
    v_fma_f32 v45, v95, v61, v45
    v_mul_f32 v46, v97, v46
    v_fma_f32 v46, v95, v62, v46
    v_mul_f32 v47, v97, v47
    v_fma_f32 v47, v95, v63, v47
    v_mov_b32 v95, v44
    v_mov_b32 v96, v44
    s_nop 1
    v_permlane32_swap_b32 v95, v96
    v_rcp_f32 v96, v96
    s_nop 0
    v_mul_f32 v32, v96, v32
    v_mul_f32 v33, v96, v33
    v_mul_f32 v34, v96, v34
    v_mul_f32 v35, v96, v35
    v_mul_f32 v36, v96, v36
    v_mul_f32 v37, v96, v37
    v_mul_f32 v38, v96, v38
    v_mul_f32 v39, v96, v39
    v_mul_f32 v40, v96, v40
    v_mul_f32 v41, v96, v41
    v_mul_f32 v42, v96, v42
    v_mul_f32 v43, v96, v43
    v_mul_f32 v44, v96, v44
    v_mul_f32 v45, v96, v45
    v_mul_f32 v46, v96, v46
    v_mul_f32 v47, v96, v47
    v_lshl_add_u32 v7, v4, 3, v7
    v_cvt_pk_bf16_f32 v64, v32, v33
    v_cvt_pk_bf16_f32 v65, v34, v35
    v_cvt_pk_bf16_f32 v66, v36, v37
    v_cvt_pk_bf16_f32 v67, v38, v39
    v_cvt_pk_bf16_f32 v68, v40, v41
    v_cvt_pk_bf16_f32 v69, v42, v43
    v_cvt_pk_bf16_f32 v70, v44, v45
    v_cvt_pk_bf16_f32 v71, v46, v47
    buffer_store_dwordx2 v[64:65], v7, s[32:35], 0 offen offset:0
    buffer_store_dwordx2 v[66:67], v7, s[32:35], 0 offen offset:16
    buffer_store_dwordx2 v[68:69], v7, s[32:35], 0 offen offset:32
    v_cmp_gt_u32 vcc, 32, v1
    v_mov_b32 v9, 0x40000000
    s_nop 1
    v_cndmask_b32 v9, v9, v7, vcc
    buffer_store_dwordx2 v[70:71], v9, s[32:35], 0 offen offset:48
    s_endpgm
k2_b:
    s_add_u32 s24, s20, 0x300000
    s_addc_u32 s25, s21, 0
    s_and_b32 s25, s25, 0xffff
    s_mov_b32 s26, 0x540000
    s_mov_b32 s27, 0x00020000
    s_add_u32 s32, s20, 0xb00000
    s_addc_u32 s33, s21, 0
    s_and_b32 s33, s33, 0xffff
    s_mov_b32 s34, 0x1c0000
    s_mov_b32 s35, 0x00020000
    s_lshl_b32 s40, s2, 7
    v_and_b32 v1, 127, v0
    v_add_u32 v1, s40, v1
    v_lshrrev_b32 v2, 4, v1
    v_and_b32 v3, 15, v1
    v_mul_u32_u24 v3, 56, v3
    s_mov_b32 s40, 2688
    v_mul_lo_u32 v4, v2, s40
    v_add_u32 v4, v4, v3
    buffer_load_dwordx2 v[10:11], v4, s[24:27], 0 offen offset:0
    buffer_load_dwordx2 v[12:13], v4, s[24:27], 0 offen offset:8
    buffer_load_dwordx2 v[14:15], v4, s[24:27], 0 offen offset:16
    buffer_load_dwordx2 v[16:17], v4, s[24:27], 0 offen offset:24
    buffer_load_dwordx2 v[18:19], v4, s[24:27], 0 offen offset:32
    buffer_load_dwordx2 v[20:21], v4, s[24:27], 0 offen offset:40
    buffer_load_dwordx2 v[22:23], v4, s[24:27], 0 offen offset:48
    v_subrev_u32 v5, 0, v2
    v_max_i32 v5, 0, v5
    v_mul_lo_u32 v5, v5, s40
    v_add_u32 v100, v5, v3
    v_subrev_u32 v5, 2, v2
    v_max_i32 v5, 0, v5
    v_mul_lo_u32 v5, v5, s40
    v_add_u32 v101, v5, v3
    v_subrev_u32 v5, 4, v2
    v_max_i32 v5, 0, v5
    v_mul_lo_u32 v5, v5, s40
    v_add_u32 v102, v5, v3
    v_subrev_u32 v5, 6, v2
    v_max_i32 v5, 0, v5
    v_mul_lo_u32 v5, v5, s40
    v_add_u32 v103, v5, v3
    v_subrev_u32 v5, 8, v2
    v_max_i32 v5, 0, v5
    v_mul_lo_u32 v5, v5, s40
    v_add_u32 v104, v5, v3
    v_subrev_u32 v5, 10, v2
    v_max_i32 v5, 0, v5
    v_mul_lo_u32 v5, v5, s40
    v_add_u32 v105, v5, v3
    v_subrev_u32 v5, 12, v2
    v_max_i32 v5, 0, v5
    v_mul_lo_u32 v5, v5, s40
    v_add_u32 v106, v5, v3
    v_subrev_u32 v5, 14, v2
    v_max_i32 v5, 0, v5
    v_mul_lo_u32 v5, v5, s40
    v_add_u32 v107, v5, v3
    buffer_load_dwordx2 v[44:45], v100, s[24:27], 0 offen offset:896
    buffer_load_dwordx2 v[46:47], v100, s[24:27], 0 offen offset:904
    buffer_load_dwordx2 v[48:49], v100, s[24:27], 0 offen offset:912
    buffer_load_dwordx2 v[50:51], v100, s[24:27], 0 offen offset:920
    buffer_load_dwordx2 v[52:53], v100, s[24:27], 0 offen offset:928
    buffer_load_dwordx2 v[54:55], v100, s[24:27], 0 offen offset:936
    buffer_load_dwordx2 v[56:57], v100, s[24:27], 0 offen offset:944
    buffer_load_dwordx2 v[58:59], v101, s[24:27], 0 offen offset:896
    buffer_load_dwordx2 v[60:61], v101, s[24:27], 0 offen offset:904
    buffer_load_dwordx2 v[62:63], v101, s[24:27], 0 offen offset:912
    buffer_load_dwordx2 v[64:65], v101, s[24:27], 0 offen offset:920
    buffer_load_dwordx2 v[66:67], v101, s[24:27], 0 offen offset:928
    buffer_load_dwordx2 v[68:69], v101, s[24:27], 0 offen offset:936
    buffer_load_dwordx2 v[70:71], v101, s[24:27], 0 offen offset:944
    buffer_load_dwordx2 v[72:73], v102, s[24:27], 0 offen offset:896
    buffer_load_dwordx2 v[74:75], v102, s[24:27], 0 offen offset:904
    buffer_load_dwordx2 v[76:77], v102, s[24:27], 0 offen offset:912
    buffer_load_dwordx2 v[78:79], v102, s[24:27], 0 offen offset:920
    buffer_load_dwordx2 v[80:81], v102, s[24:27], 0 offen offset:928
    buffer_load_dwordx2 v[82:83], v102, s[24:27], 0 offen offset:936
    buffer_load_dwordx2 v[84:85], v102, s[24:27], 0 offen offset:944
    buffer_load_dwordx2 v[86:87], v103, s[24:27], 0 offen offset:896
    buffer_load_dwordx2 v[88:89], v103, s[24:27], 0 offen offset:904
    buffer_load_dwordx2 v[90:91], v103, s[24:27], 0 offen offset:912
    buffer_load_dwordx2 v[92:93], v103, s[24:27], 0 offen offset:920
    buffer_load_dwordx2 v[94:95], v103, s[24:27], 0 offen offset:928
    buffer_load_dwordx2 v[96:97], v103, s[24:27], 0 offen offset:936
    buffer_load_dwordx2 v[98:99], v103, s[24:27], 0 offen offset:944
    s_waitcnt vmcnt(21)
    v_mov_b32 v108, 0
    v_dot2_f32_bf16 v108, v10, v44, v108
    v_dot2_f32_bf16 v108, v11, v45, v108
    v_dot2_f32_bf16 v108, v12, v46, v108
    v_dot2_f32_bf16 v108, v13, v47, v108
    v_dot2_f32_bf16 v108, v14, v48, v108
    v_dot2_f32_bf16 v108, v15, v49, v108
    v_dot2_f32_bf16 v108, v16, v50, v108
    v_dot2_f32_bf16 v108, v17, v51, v108
    v_dot2_f32_bf16 v108, v18, v52, v108
    v_dot2_f32_bf16 v108, v19, v53, v108
    v_dot2_f32_bf16 v108, v20, v54, v108
    v_dot2_f32_bf16 v108, v21, v55, v108
    v_dot2_f32_bf16 v108, v22, v56, v108
    v_dot2_f32_bf16 v108, v23, v57, v108
    s_nop 2
    v_cvt_pk_bf16_f32 v6, v108, v108
    v_lshlrev_b32 v6, 16, v6
    v_mul_f32 v6, 0x3e41848f, v6
    v_cvt_pk_bf16_f32 v6, v6, v6
    v_lshlrev_b32 v6, 16, v6
    v_cmp_le_u32 vcc, 0, v2
    v_mov_b32 v7, 0xce6e6b28
    s_nop 1
    v_cndmask_b32 v108, v7, v6, vcc
    s_waitcnt vmcnt(14)
    v_mov_b32 v109, 0
    v_dot2_f32_bf16 v109, v10, v58, v109
    v_dot2_f32_bf16 v109, v11, v59, v109
    v_dot2_f32_bf16 v109, v12, v60, v109
    v_dot2_f32_bf16 v109, v13, v61, v109
    v_dot2_f32_bf16 v109, v14, v62, v109
    v_dot2_f32_bf16 v109, v15, v63, v109
    v_dot2_f32_bf16 v109, v16, v64, v109
    v_dot2_f32_bf16 v109, v17, v65, v109
    v_dot2_f32_bf16 v109, v18, v66, v109
    v_dot2_f32_bf16 v109, v19, v67, v109
    v_dot2_f32_bf16 v109, v20, v68, v109
    v_dot2_f32_bf16 v109, v21, v69, v109
    v_dot2_f32_bf16 v109, v22, v70, v109
    v_dot2_f32_bf16 v109, v23, v71, v109
    s_nop 2
    v_cvt_pk_bf16_f32 v6, v109, v109
    v_lshlrev_b32 v6, 16, v6
    v_mul_f32 v6, 0x3e41848f, v6
    v_cvt_pk_bf16_f32 v6, v6, v6
    v_lshlrev_b32 v6, 16, v6
    v_cmp_le_u32 vcc, 2, v2
    v_mov_b32 v7, 0xce6e6b28
    s_nop 1
    v_cndmask_b32 v109, v7, v6, vcc
    s_waitcnt vmcnt(7)
    v_mov_b32 v110, 0
    v_dot2_f32_bf16 v110, v10, v72, v110
    v_dot2_f32_bf16 v110, v11, v73, v110
    v_dot2_f32_bf16 v110, v12, v74, v110
    v_dot2_f32_bf16 v110, v13, v75, v110
    v_dot2_f32_bf16 v110, v14, v76, v110
    v_dot2_f32_bf16 v110, v15, v77, v110
    v_dot2_f32_bf16 v110, v16, v78, v110
    v_dot2_f32_bf16 v110, v17, v79, v110
    v_dot2_f32_bf16 v110, v18, v80, v110
    v_dot2_f32_bf16 v110, v19, v81, v110
    v_dot2_f32_bf16 v110, v20, v82, v110
    v_dot2_f32_bf16 v110, v21, v83, v110
    v_dot2_f32_bf16 v110, v22, v84, v110
    v_dot2_f32_bf16 v110, v23, v85, v110
    s_nop 2
    v_cvt_pk_bf16_f32 v6, v110, v110
    v_lshlrev_b32 v6, 16, v6
    v_mul_f32 v6, 0x3e41848f, v6
    v_cvt_pk_bf16_f32 v6, v6, v6
    v_lshlrev_b32 v6, 16, v6
    v_cmp_le_u32 vcc, 4, v2
    v_mov_b32 v7, 0xce6e6b28
    s_nop 1
    v_cndmask_b32 v110, v7, v6, vcc
    s_waitcnt vmcnt(0)
    v_mov_b32 v111, 0
    v_dot2_f32_bf16 v111, v10, v86, v111
    v_dot2_f32_bf16 v111, v11, v87, v111
    v_dot2_f32_bf16 v111, v12, v88, v111
    v_dot2_f32_bf16 v111, v13, v89, v111
    v_dot2_f32_bf16 v111, v14, v90, v111
    v_dot2_f32_bf16 v111, v15, v91, v111
    v_dot2_f32_bf16 v111, v16, v92, v111
    v_dot2_f32_bf16 v111, v17, v93, v111
    v_dot2_f32_bf16 v111, v18, v94, v111
    v_dot2_f32_bf16 v111, v19, v95, v111
    v_dot2_f32_bf16 v111, v20, v96, v111
    v_dot2_f32_bf16 v111, v21, v97, v111
    v_dot2_f32_bf16 v111, v22, v98, v111
    v_dot2_f32_bf16 v111, v23, v99, v111
    s_nop 2
    v_cvt_pk_bf16_f32 v6, v111, v111
    v_lshlrev_b32 v6, 16, v6
    v_mul_f32 v6, 0x3e41848f, v6
    v_cvt_pk_bf16_f32 v6, v6, v6
    v_lshlrev_b32 v6, 16, v6
    v_cmp_le_u32 vcc, 6, v2
    v_mov_b32 v7, 0xce6e6b28
    s_nop 1
    v_cndmask_b32 v111, v7, v6, vcc
    s_barrier
    buffer_load_dwordx2 v[44:45], v104, s[24:27], 0 offen offset:896
    buffer_load_dwordx2 v[46:47], v104, s[24:27], 0 offen offset:904
    buffer_load_dwordx2 v[48:49], v104, s[24:27], 0 offen offset:912
    buffer_load_dwordx2 v[50:51], v104, s[24:27], 0 offen offset:920
    buffer_load_dwordx2 v[52:53], v104, s[24:27], 0 offen offset:928
    buffer_load_dwordx2 v[54:55], v104, s[24:27], 0 offen offset:936
    buffer_load_dwordx2 v[56:57], v104, s[24:27], 0 offen offset:944
    buffer_load_dwordx2 v[58:59], v105, s[24:27], 0 offen offset:896
    buffer_load_dwordx2 v[60:61], v105, s[24:27], 0 offen offset:904
    buffer_load_dwordx2 v[62:63], v105, s[24:27], 0 offen offset:912
    buffer_load_dwordx2 v[64:65], v105, s[24:27], 0 offen offset:920
    buffer_load_dwordx2 v[66:67], v105, s[24:27], 0 offen offset:928
    buffer_load_dwordx2 v[68:69], v105, s[24:27], 0 offen offset:936
    buffer_load_dwordx2 v[70:71], v105, s[24:27], 0 offen offset:944
    buffer_load_dwordx2 v[72:73], v106, s[24:27], 0 offen offset:896
    buffer_load_dwordx2 v[74:75], v106, s[24:27], 0 offen offset:904
    buffer_load_dwordx2 v[76:77], v106, s[24:27], 0 offen offset:912
    buffer_load_dwordx2 v[78:79], v106, s[24:27], 0 offen offset:920
    buffer_load_dwordx2 v[80:81], v106, s[24:27], 0 offen offset:928
    buffer_load_dwordx2 v[82:83], v106, s[24:27], 0 offen offset:936
    buffer_load_dwordx2 v[84:85], v106, s[24:27], 0 offen offset:944
    buffer_load_dwordx2 v[86:87], v107, s[24:27], 0 offen offset:896
    buffer_load_dwordx2 v[88:89], v107, s[24:27], 0 offen offset:904
    buffer_load_dwordx2 v[90:91], v107, s[24:27], 0 offen offset:912
    buffer_load_dwordx2 v[92:93], v107, s[24:27], 0 offen offset:920
    buffer_load_dwordx2 v[94:95], v107, s[24:27], 0 offen offset:928
    buffer_load_dwordx2 v[96:97], v107, s[24:27], 0 offen offset:936
    buffer_load_dwordx2 v[98:99], v107, s[24:27], 0 offen offset:944
    s_waitcnt vmcnt(21)
    v_mov_b32 v112, 0
    v_dot2_f32_bf16 v112, v10, v44, v112
    v_dot2_f32_bf16 v112, v11, v45, v112
    v_dot2_f32_bf16 v112, v12, v46, v112
    v_dot2_f32_bf16 v112, v13, v47, v112
    v_dot2_f32_bf16 v112, v14, v48, v112
    v_dot2_f32_bf16 v112, v15, v49, v112
    v_dot2_f32_bf16 v112, v16, v50, v112
    v_dot2_f32_bf16 v112, v17, v51, v112
    v_dot2_f32_bf16 v112, v18, v52, v112
    v_dot2_f32_bf16 v112, v19, v53, v112
    v_dot2_f32_bf16 v112, v20, v54, v112
    v_dot2_f32_bf16 v112, v21, v55, v112
    v_dot2_f32_bf16 v112, v22, v56, v112
    v_dot2_f32_bf16 v112, v23, v57, v112
    s_nop 2
    v_cvt_pk_bf16_f32 v6, v112, v112
    v_lshlrev_b32 v6, 16, v6
    v_mul_f32 v6, 0x3e41848f, v6
    v_cvt_pk_bf16_f32 v6, v6, v6
    v_lshlrev_b32 v6, 16, v6
    v_cmp_le_u32 vcc, 8, v2
    v_mov_b32 v7, 0xce6e6b28
    s_nop 1
    v_cndmask_b32 v112, v7, v6, vcc
    s_waitcnt vmcnt(14)
    v_mov_b32 v113, 0
    v_dot2_f32_bf16 v113, v10, v58, v113
    v_dot2_f32_bf16 v113, v11, v59, v113
    v_dot2_f32_bf16 v113, v12, v60, v113
    v_dot2_f32_bf16 v113, v13, v61, v113
    v_dot2_f32_bf16 v113, v14, v62, v113
    v_dot2_f32_bf16 v113, v15, v63, v113
    v_dot2_f32_bf16 v113, v16, v64, v113
    v_dot2_f32_bf16 v113, v17, v65, v113
    v_dot2_f32_bf16 v113, v18, v66, v113
    v_dot2_f32_bf16 v113, v19, v67, v113
    v_dot2_f32_bf16 v113, v20, v68, v113
    v_dot2_f32_bf16 v113, v21, v69, v113
    v_dot2_f32_bf16 v113, v22, v70, v113
    v_dot2_f32_bf16 v113, v23, v71, v113
    s_nop 2
    v_cvt_pk_bf16_f32 v6, v113, v113
    v_lshlrev_b32 v6, 16, v6
    v_mul_f32 v6, 0x3e41848f, v6
    v_cvt_pk_bf16_f32 v6, v6, v6
    v_lshlrev_b32 v6, 16, v6
    v_cmp_le_u32 vcc, 10, v2
    v_mov_b32 v7, 0xce6e6b28
    s_nop 1
    v_cndmask_b32 v113, v7, v6, vcc
    s_waitcnt vmcnt(7)
    v_mov_b32 v114, 0
    v_dot2_f32_bf16 v114, v10, v72, v114
    v_dot2_f32_bf16 v114, v11, v73, v114
    v_dot2_f32_bf16 v114, v12, v74, v114
    v_dot2_f32_bf16 v114, v13, v75, v114
    v_dot2_f32_bf16 v114, v14, v76, v114
    v_dot2_f32_bf16 v114, v15, v77, v114
    v_dot2_f32_bf16 v114, v16, v78, v114
    v_dot2_f32_bf16 v114, v17, v79, v114
    v_dot2_f32_bf16 v114, v18, v80, v114
    v_dot2_f32_bf16 v114, v19, v81, v114
    v_dot2_f32_bf16 v114, v20, v82, v114
    v_dot2_f32_bf16 v114, v21, v83, v114
    v_dot2_f32_bf16 v114, v22, v84, v114
    v_dot2_f32_bf16 v114, v23, v85, v114
    s_nop 2
    v_cvt_pk_bf16_f32 v6, v114, v114
    v_lshlrev_b32 v6, 16, v6
    v_mul_f32 v6, 0x3e41848f, v6
    v_cvt_pk_bf16_f32 v6, v6, v6
    v_lshlrev_b32 v6, 16, v6
    v_cmp_le_u32 vcc, 12, v2
    v_mov_b32 v7, 0xce6e6b28
    s_nop 1
    v_cndmask_b32 v114, v7, v6, vcc
    s_waitcnt vmcnt(0)
    v_mov_b32 v115, 0
    v_dot2_f32_bf16 v115, v10, v86, v115
    v_dot2_f32_bf16 v115, v11, v87, v115
    v_dot2_f32_bf16 v115, v12, v88, v115
    v_dot2_f32_bf16 v115, v13, v89, v115
    v_dot2_f32_bf16 v115, v14, v90, v115
    v_dot2_f32_bf16 v115, v15, v91, v115
    v_dot2_f32_bf16 v115, v16, v92, v115
    v_dot2_f32_bf16 v115, v17, v93, v115
    v_dot2_f32_bf16 v115, v18, v94, v115
    v_dot2_f32_bf16 v115, v19, v95, v115
    v_dot2_f32_bf16 v115, v20, v96, v115
    v_dot2_f32_bf16 v115, v21, v97, v115
    v_dot2_f32_bf16 v115, v22, v98, v115
    v_dot2_f32_bf16 v115, v23, v99, v115
    s_nop 2
    v_cvt_pk_bf16_f32 v6, v115, v115
    v_lshlrev_b32 v6, 16, v6
    v_mul_f32 v6, 0x3e41848f, v6
    v_cvt_pk_bf16_f32 v6, v6, v6
    v_lshlrev_b32 v6, 16, v6
    v_cmp_le_u32 vcc, 14, v2
    v_mov_b32 v7, 0xce6e6b28
    s_nop 1
    v_cndmask_b32 v115, v7, v6, vcc
    s_barrier
    v_max3_f32 v6, v108, v109, v110
    v_max3_f32 v6, v6, v111, v112
    v_max3_f32 v6, v6, v113, v114
    v_max_f32 v6, v6, v115
    v_mov_b32 v7, 0
    v_sub_f32 v108, v108, v6
    v_mul_f32 v108, 0x3fb8aa3b, v108
    v_exp_f32 v108, v108
    s_nop 0
    v_add_f32 v7, v7, v108
    v_sub_f32 v109, v109, v6
    v_mul_f32 v109, 0x3fb8aa3b, v109
    v_exp_f32 v109, v109
    s_nop 0
    v_add_f32 v7, v7, v109
    v_sub_f32 v110, v110, v6
    v_mul_f32 v110, 0x3fb8aa3b, v110
    v_exp_f32 v110, v110
    s_nop 0
    v_add_f32 v7, v7, v110
    v_sub_f32 v111, v111, v6
    v_mul_f32 v111, 0x3fb8aa3b, v111
    v_exp_f32 v111, v111
    s_nop 0
    v_add_f32 v7, v7, v111
    v_sub_f32 v112, v112, v6
    v_mul_f32 v112, 0x3fb8aa3b, v112
    v_exp_f32 v112, v112
    s_nop 0
    v_add_f32 v7, v7, v112
    v_sub_f32 v113, v113, v6
    v_mul_f32 v113, 0x3fb8aa3b, v113
    v_exp_f32 v113, v113
    s_nop 0
    v_add_f32 v7, v7, v113
    v_sub_f32 v114, v114, v6
    v_mul_f32 v114, 0x3fb8aa3b, v114
    v_exp_f32 v114, v114
    s_nop 0
    v_add_f32 v7, v7, v114
    v_sub_f32 v115, v115, v6
    v_mul_f32 v115, 0x3fb8aa3b, v115
    v_exp_f32 v115, v115
    s_nop 0
    v_add_f32 v7, v7, v115
    v_rcp_f32 v7, v7
    s_nop 0
    v_mul_f32 v108, v7, v108
    v_cvt_pk_bf16_f32 v108, v108, v108
    v_lshlrev_b32 v108, 16, v108
    v_mul_f32 v109, v7, v109
    v_cvt_pk_bf16_f32 v109, v109, v109
    v_lshlrev_b32 v109, 16, v109
    v_mul_f32 v110, v7, v110
    v_cvt_pk_bf16_f32 v110, v110, v110
    v_lshlrev_b32 v110, 16, v110
    v_mul_f32 v111, v7, v111
    v_cvt_pk_bf16_f32 v111, v111, v111
    v_lshlrev_b32 v111, 16, v111
    v_mul_f32 v112, v7, v112
    v_cvt_pk_bf16_f32 v112, v112, v112
    v_lshlrev_b32 v112, 16, v112
    v_mul_f32 v113, v7, v113
    v_cvt_pk_bf16_f32 v113, v113, v113
    v_lshlrev_b32 v113, 16, v113
    v_mul_f32 v114, v7, v114
    v_cvt_pk_bf16_f32 v114, v114, v114
    v_lshlrev_b32 v114, 16, v114
    v_mul_f32 v115, v7, v115
    v_cvt_pk_bf16_f32 v115, v115, v115
    v_lshlrev_b32 v115, 16, v115
    v_mov_b32 v10, 0
    v_mov_b32 v11, 0
    v_mov_b32 v12, 0
    v_mov_b32 v13, 0
    v_mov_b32 v14, 0
    v_mov_b32 v15, 0
    v_mov_b32 v16, 0
    v_mov_b32 v17, 0
    v_mov_b32 v18, 0
    v_mov_b32 v19, 0
    v_mov_b32 v20, 0
    v_mov_b32 v21, 0
    v_mov_b32 v22, 0
    v_mov_b32 v23, 0
    v_mov_b32 v24, 0
    v_mov_b32 v25, 0
    v_mov_b32 v26, 0
    v_mov_b32 v27, 0
    v_mov_b32 v28, 0
    v_mov_b32 v29, 0
    v_mov_b32 v30, 0
    v_mov_b32 v31, 0
    v_mov_b32 v32, 0
    v_mov_b32 v33, 0
    v_mov_b32 v34, 0
    v_mov_b32 v35, 0
    v_mov_b32 v36, 0
    v_mov_b32 v37, 0
    buffer_load_dwordx2 v[44:45], v100, s[24:27], 0 offen offset:1792
    buffer_load_dwordx2 v[46:47], v100, s[24:27], 0 offen offset:1800
    buffer_load_dwordx2 v[48:49], v100, s[24:27], 0 offen offset:1808
    buffer_load_dwordx2 v[50:51], v100, s[24:27], 0 offen offset:1816
    buffer_load_dwordx2 v[52:53], v100, s[24:27], 0 offen offset:1824
    buffer_load_dwordx2 v[54:55], v100, s[24:27], 0 offen offset:1832
    buffer_load_dwordx2 v[56:57], v100, s[24:27], 0 offen offset:1840
    buffer_load_dwordx2 v[58:59], v101, s[24:27], 0 offen offset:1792
    buffer_load_dwordx2 v[60:61], v101, s[24:27], 0 offen offset:1800
    buffer_load_dwordx2 v[62:63], v101, s[24:27], 0 offen offset:1808
    buffer_load_dwordx2 v[64:65], v101, s[24:27], 0 offen offset:1816
    buffer_load_dwordx2 v[66:67], v101, s[24:27], 0 offen offset:1824
    buffer_load_dwordx2 v[68:69], v101, s[24:27], 0 offen offset:1832
    buffer_load_dwordx2 v[70:71], v101, s[24:27], 0 offen offset:1840
    buffer_load_dwordx2 v[72:73], v102, s[24:27], 0 offen offset:1792
    buffer_load_dwordx2 v[74:75], v102, s[24:27], 0 offen offset:1800
    buffer_load_dwordx2 v[76:77], v102, s[24:27], 0 offen offset:1808
    buffer_load_dwordx2 v[78:79], v102, s[24:27], 0 offen offset:1816
    buffer_load_dwordx2 v[80:81], v102, s[24:27], 0 offen offset:1824
    buffer_load_dwordx2 v[82:83], v102, s[24:27], 0 offen offset:1832
    buffer_load_dwordx2 v[84:85], v102, s[24:27], 0 offen offset:1840
    buffer_load_dwordx2 v[86:87], v103, s[24:27], 0 offen offset:1792
    buffer_load_dwordx2 v[88:89], v103, s[24:27], 0 offen offset:1800
    buffer_load_dwordx2 v[90:91], v103, s[24:27], 0 offen offset:1808
    buffer_load_dwordx2 v[92:93], v103, s[24:27], 0 offen offset:1816
    buffer_load_dwordx2 v[94:95], v103, s[24:27], 0 offen offset:1824
    buffer_load_dwordx2 v[96:97], v103, s[24:27], 0 offen offset:1832
    buffer_load_dwordx2 v[98:99], v103, s[24:27], 0 offen offset:1840
    s_waitcnt vmcnt(21)
    v_lshlrev_b32 v6, 16, v44
    v_and_b32 v7, 0xffff0000, v44
    v_fmac_f32 v10, v108, v6
    v_fmac_f32 v11, v108, v7
    v_lshlrev_b32 v6, 16, v45
    v_and_b32 v7, 0xffff0000, v45
    v_fmac_f32 v12, v108, v6
    v_fmac_f32 v13, v108, v7
    v_lshlrev_b32 v6, 16, v46
    v_and_b32 v7, 0xffff0000, v46
    v_fmac_f32 v14, v108, v6
    v_fmac_f32 v15, v108, v7
    v_lshlrev_b32 v6, 16, v47
    v_and_b32 v7, 0xffff0000, v47
    v_fmac_f32 v16, v108, v6
    v_fmac_f32 v17, v108, v7
    v_lshlrev_b32 v6, 16, v48
    v_and_b32 v7, 0xffff0000, v48
    v_fmac_f32 v18, v108, v6
    v_fmac_f32 v19, v108, v7
    v_lshlrev_b32 v6, 16, v49
    v_and_b32 v7, 0xffff0000, v49
    v_fmac_f32 v20, v108, v6
    v_fmac_f32 v21, v108, v7
    v_lshlrev_b32 v6, 16, v50
    v_and_b32 v7, 0xffff0000, v50
    v_fmac_f32 v22, v108, v6
    v_fmac_f32 v23, v108, v7
    v_lshlrev_b32 v6, 16, v51
    v_and_b32 v7, 0xffff0000, v51
    v_fmac_f32 v24, v108, v6
    v_fmac_f32 v25, v108, v7
    v_lshlrev_b32 v6, 16, v52
    v_and_b32 v7, 0xffff0000, v52
    v_fmac_f32 v26, v108, v6
    v_fmac_f32 v27, v108, v7
    v_lshlrev_b32 v6, 16, v53
    v_and_b32 v7, 0xffff0000, v53
    v_fmac_f32 v28, v108, v6
    v_fmac_f32 v29, v108, v7
    v_lshlrev_b32 v6, 16, v54
    v_and_b32 v7, 0xffff0000, v54
    v_fmac_f32 v30, v108, v6
    v_fmac_f32 v31, v108, v7
    v_lshlrev_b32 v6, 16, v55
    v_and_b32 v7, 0xffff0000, v55
    v_fmac_f32 v32, v108, v6
    v_fmac_f32 v33, v108, v7
    v_lshlrev_b32 v6, 16, v56
    v_and_b32 v7, 0xffff0000, v56
    v_fmac_f32 v34, v108, v6
    v_fmac_f32 v35, v108, v7
    v_lshlrev_b32 v6, 16, v57
    v_and_b32 v7, 0xffff0000, v57
    v_fmac_f32 v36, v108, v6
    v_fmac_f32 v37, v108, v7
    s_waitcnt vmcnt(14)
    v_lshlrev_b32 v6, 16, v58
    v_and_b32 v7, 0xffff0000, v58
    v_fmac_f32 v10, v109, v6
    v_fmac_f32 v11, v109, v7
    v_lshlrev_b32 v6, 16, v59
    v_and_b32 v7, 0xffff0000, v59
    v_fmac_f32 v12, v109, v6
    v_fmac_f32 v13, v109, v7
    v_lshlrev_b32 v6, 16, v60
    v_and_b32 v7, 0xffff0000, v60
    v_fmac_f32 v14, v109, v6
    v_fmac_f32 v15, v109, v7
    v_lshlrev_b32 v6, 16, v61
    v_and_b32 v7, 0xffff0000, v61
    v_fmac_f32 v16, v109, v6
    v_fmac_f32 v17, v109, v7
    v_lshlrev_b32 v6, 16, v62
    v_and_b32 v7, 0xffff0000, v62
    v_fmac_f32 v18, v109, v6
    v_fmac_f32 v19, v109, v7
    v_lshlrev_b32 v6, 16, v63
    v_and_b32 v7, 0xffff0000, v63
    v_fmac_f32 v20, v109, v6
    v_fmac_f32 v21, v109, v7
    v_lshlrev_b32 v6, 16, v64
    v_and_b32 v7, 0xffff0000, v64
    v_fmac_f32 v22, v109, v6
    v_fmac_f32 v23, v109, v7
    v_lshlrev_b32 v6, 16, v65
    v_and_b32 v7, 0xffff0000, v65
    v_fmac_f32 v24, v109, v6
    v_fmac_f32 v25, v109, v7
    v_lshlrev_b32 v6, 16, v66
    v_and_b32 v7, 0xffff0000, v66
    v_fmac_f32 v26, v109, v6
    v_fmac_f32 v27, v109, v7
    v_lshlrev_b32 v6, 16, v67
    v_and_b32 v7, 0xffff0000, v67
    v_fmac_f32 v28, v109, v6
    v_fmac_f32 v29, v109, v7
    v_lshlrev_b32 v6, 16, v68
    v_and_b32 v7, 0xffff0000, v68
    v_fmac_f32 v30, v109, v6
    v_fmac_f32 v31, v109, v7
    v_lshlrev_b32 v6, 16, v69
    v_and_b32 v7, 0xffff0000, v69
    v_fmac_f32 v32, v109, v6
    v_fmac_f32 v33, v109, v7
    v_lshlrev_b32 v6, 16, v70
    v_and_b32 v7, 0xffff0000, v70
    v_fmac_f32 v34, v109, v6
    v_fmac_f32 v35, v109, v7
    v_lshlrev_b32 v6, 16, v71
    v_and_b32 v7, 0xffff0000, v71
    v_fmac_f32 v36, v109, v6
    v_fmac_f32 v37, v109, v7
    s_waitcnt vmcnt(7)
    v_lshlrev_b32 v6, 16, v72
    v_and_b32 v7, 0xffff0000, v72
    v_fmac_f32 v10, v110, v6
    v_fmac_f32 v11, v110, v7
    v_lshlrev_b32 v6, 16, v73
    v_and_b32 v7, 0xffff0000, v73
    v_fmac_f32 v12, v110, v6
    v_fmac_f32 v13, v110, v7
    v_lshlrev_b32 v6, 16, v74
    v_and_b32 v7, 0xffff0000, v74
    v_fmac_f32 v14, v110, v6
    v_fmac_f32 v15, v110, v7
    v_lshlrev_b32 v6, 16, v75
    v_and_b32 v7, 0xffff0000, v75
    v_fmac_f32 v16, v110, v6
    v_fmac_f32 v17, v110, v7
    v_lshlrev_b32 v6, 16, v76
    v_and_b32 v7, 0xffff0000, v76
    v_fmac_f32 v18, v110, v6
    v_fmac_f32 v19, v110, v7
    v_lshlrev_b32 v6, 16, v77
    v_and_b32 v7, 0xffff0000, v77
    v_fmac_f32 v20, v110, v6
    v_fmac_f32 v21, v110, v7
    v_lshlrev_b32 v6, 16, v78
    v_and_b32 v7, 0xffff0000, v78
    v_fmac_f32 v22, v110, v6
    v_fmac_f32 v23, v110, v7
    v_lshlrev_b32 v6, 16, v79
    v_and_b32 v7, 0xffff0000, v79
    v_fmac_f32 v24, v110, v6
    v_fmac_f32 v25, v110, v7
    v_lshlrev_b32 v6, 16, v80
    v_and_b32 v7, 0xffff0000, v80
    v_fmac_f32 v26, v110, v6
    v_fmac_f32 v27, v110, v7
    v_lshlrev_b32 v6, 16, v81
    v_and_b32 v7, 0xffff0000, v81
    v_fmac_f32 v28, v110, v6
    v_fmac_f32 v29, v110, v7
    v_lshlrev_b32 v6, 16, v82
    v_and_b32 v7, 0xffff0000, v82
    v_fmac_f32 v30, v110, v6
    v_fmac_f32 v31, v110, v7
    v_lshlrev_b32 v6, 16, v83
    v_and_b32 v7, 0xffff0000, v83
    v_fmac_f32 v32, v110, v6
    v_fmac_f32 v33, v110, v7
    v_lshlrev_b32 v6, 16, v84
    v_and_b32 v7, 0xffff0000, v84
    v_fmac_f32 v34, v110, v6
    v_fmac_f32 v35, v110, v7
    v_lshlrev_b32 v6, 16, v85
    v_and_b32 v7, 0xffff0000, v85
    v_fmac_f32 v36, v110, v6
    v_fmac_f32 v37, v110, v7
    s_waitcnt vmcnt(0)
    v_lshlrev_b32 v6, 16, v86
    v_and_b32 v7, 0xffff0000, v86
    v_fmac_f32 v10, v111, v6
    v_fmac_f32 v11, v111, v7
    v_lshlrev_b32 v6, 16, v87
    v_and_b32 v7, 0xffff0000, v87
    v_fmac_f32 v12, v111, v6
    v_fmac_f32 v13, v111, v7
    v_lshlrev_b32 v6, 16, v88
    v_and_b32 v7, 0xffff0000, v88
    v_fmac_f32 v14, v111, v6
    v_fmac_f32 v15, v111, v7
    v_lshlrev_b32 v6, 16, v89
    v_and_b32 v7, 0xffff0000, v89
    v_fmac_f32 v16, v111, v6
    v_fmac_f32 v17, v111, v7
    v_lshlrev_b32 v6, 16, v90
    v_and_b32 v7, 0xffff0000, v90
    v_fmac_f32 v18, v111, v6
    v_fmac_f32 v19, v111, v7
    v_lshlrev_b32 v6, 16, v91
    v_and_b32 v7, 0xffff0000, v91
    v_fmac_f32 v20, v111, v6
    v_fmac_f32 v21, v111, v7
    v_lshlrev_b32 v6, 16, v92
    v_and_b32 v7, 0xffff0000, v92
    v_fmac_f32 v22, v111, v6
    v_fmac_f32 v23, v111, v7
    v_lshlrev_b32 v6, 16, v93
    v_and_b32 v7, 0xffff0000, v93
    v_fmac_f32 v24, v111, v6
    v_fmac_f32 v25, v111, v7
    v_lshlrev_b32 v6, 16, v94
    v_and_b32 v7, 0xffff0000, v94
    v_fmac_f32 v26, v111, v6
    v_fmac_f32 v27, v111, v7
    v_lshlrev_b32 v6, 16, v95
    v_and_b32 v7, 0xffff0000, v95
    v_fmac_f32 v28, v111, v6
    v_fmac_f32 v29, v111, v7
    v_lshlrev_b32 v6, 16, v96
    v_and_b32 v7, 0xffff0000, v96
    v_fmac_f32 v30, v111, v6
    v_fmac_f32 v31, v111, v7
    v_lshlrev_b32 v6, 16, v97
    v_and_b32 v7, 0xffff0000, v97
    v_fmac_f32 v32, v111, v6
    v_fmac_f32 v33, v111, v7
    v_lshlrev_b32 v6, 16, v98
    v_and_b32 v7, 0xffff0000, v98
    v_fmac_f32 v34, v111, v6
    v_fmac_f32 v35, v111, v7
    v_lshlrev_b32 v6, 16, v99
    v_and_b32 v7, 0xffff0000, v99
    v_fmac_f32 v36, v111, v6
    v_fmac_f32 v37, v111, v7
    s_barrier
    buffer_load_dwordx2 v[44:45], v104, s[24:27], 0 offen offset:1792
    buffer_load_dwordx2 v[46:47], v104, s[24:27], 0 offen offset:1800
    buffer_load_dwordx2 v[48:49], v104, s[24:27], 0 offen offset:1808
    buffer_load_dwordx2 v[50:51], v104, s[24:27], 0 offen offset:1816
    buffer_load_dwordx2 v[52:53], v104, s[24:27], 0 offen offset:1824
    buffer_load_dwordx2 v[54:55], v104, s[24:27], 0 offen offset:1832
    buffer_load_dwordx2 v[56:57], v104, s[24:27], 0 offen offset:1840
    buffer_load_dwordx2 v[58:59], v105, s[24:27], 0 offen offset:1792
    buffer_load_dwordx2 v[60:61], v105, s[24:27], 0 offen offset:1800
    buffer_load_dwordx2 v[62:63], v105, s[24:27], 0 offen offset:1808
    buffer_load_dwordx2 v[64:65], v105, s[24:27], 0 offen offset:1816
    buffer_load_dwordx2 v[66:67], v105, s[24:27], 0 offen offset:1824
    buffer_load_dwordx2 v[68:69], v105, s[24:27], 0 offen offset:1832
    buffer_load_dwordx2 v[70:71], v105, s[24:27], 0 offen offset:1840
    buffer_load_dwordx2 v[72:73], v106, s[24:27], 0 offen offset:1792
    buffer_load_dwordx2 v[74:75], v106, s[24:27], 0 offen offset:1800
    buffer_load_dwordx2 v[76:77], v106, s[24:27], 0 offen offset:1808
    buffer_load_dwordx2 v[78:79], v106, s[24:27], 0 offen offset:1816
    buffer_load_dwordx2 v[80:81], v106, s[24:27], 0 offen offset:1824
    buffer_load_dwordx2 v[82:83], v106, s[24:27], 0 offen offset:1832
    buffer_load_dwordx2 v[84:85], v106, s[24:27], 0 offen offset:1840
    buffer_load_dwordx2 v[86:87], v107, s[24:27], 0 offen offset:1792
    buffer_load_dwordx2 v[88:89], v107, s[24:27], 0 offen offset:1800
    buffer_load_dwordx2 v[90:91], v107, s[24:27], 0 offen offset:1808
    buffer_load_dwordx2 v[92:93], v107, s[24:27], 0 offen offset:1816
    buffer_load_dwordx2 v[94:95], v107, s[24:27], 0 offen offset:1824
    buffer_load_dwordx2 v[96:97], v107, s[24:27], 0 offen offset:1832
    buffer_load_dwordx2 v[98:99], v107, s[24:27], 0 offen offset:1840
    s_waitcnt vmcnt(21)
    v_lshlrev_b32 v6, 16, v44
    v_and_b32 v7, 0xffff0000, v44
    v_fmac_f32 v10, v112, v6
    v_fmac_f32 v11, v112, v7
    v_lshlrev_b32 v6, 16, v45
    v_and_b32 v7, 0xffff0000, v45
    v_fmac_f32 v12, v112, v6
    v_fmac_f32 v13, v112, v7
    v_lshlrev_b32 v6, 16, v46
    v_and_b32 v7, 0xffff0000, v46
    v_fmac_f32 v14, v112, v6
    v_fmac_f32 v15, v112, v7
    v_lshlrev_b32 v6, 16, v47
    v_and_b32 v7, 0xffff0000, v47
    v_fmac_f32 v16, v112, v6
    v_fmac_f32 v17, v112, v7
    v_lshlrev_b32 v6, 16, v48
    v_and_b32 v7, 0xffff0000, v48
    v_fmac_f32 v18, v112, v6
    v_fmac_f32 v19, v112, v7
    v_lshlrev_b32 v6, 16, v49
    v_and_b32 v7, 0xffff0000, v49
    v_fmac_f32 v20, v112, v6
    v_fmac_f32 v21, v112, v7
    v_lshlrev_b32 v6, 16, v50
    v_and_b32 v7, 0xffff0000, v50
    v_fmac_f32 v22, v112, v6
    v_fmac_f32 v23, v112, v7
    v_lshlrev_b32 v6, 16, v51
    v_and_b32 v7, 0xffff0000, v51
    v_fmac_f32 v24, v112, v6
    v_fmac_f32 v25, v112, v7
    v_lshlrev_b32 v6, 16, v52
    v_and_b32 v7, 0xffff0000, v52
    v_fmac_f32 v26, v112, v6
    v_fmac_f32 v27, v112, v7
    v_lshlrev_b32 v6, 16, v53
    v_and_b32 v7, 0xffff0000, v53
    v_fmac_f32 v28, v112, v6
    v_fmac_f32 v29, v112, v7
    v_lshlrev_b32 v6, 16, v54
    v_and_b32 v7, 0xffff0000, v54
    v_fmac_f32 v30, v112, v6
    v_fmac_f32 v31, v112, v7
    v_lshlrev_b32 v6, 16, v55
    v_and_b32 v7, 0xffff0000, v55
    v_fmac_f32 v32, v112, v6
    v_fmac_f32 v33, v112, v7
    v_lshlrev_b32 v6, 16, v56
    v_and_b32 v7, 0xffff0000, v56
    v_fmac_f32 v34, v112, v6
    v_fmac_f32 v35, v112, v7
    v_lshlrev_b32 v6, 16, v57
    v_and_b32 v7, 0xffff0000, v57
    v_fmac_f32 v36, v112, v6
    v_fmac_f32 v37, v112, v7
    s_waitcnt vmcnt(14)
    v_lshlrev_b32 v6, 16, v58
    v_and_b32 v7, 0xffff0000, v58
    v_fmac_f32 v10, v113, v6
    v_fmac_f32 v11, v113, v7
    v_lshlrev_b32 v6, 16, v59
    v_and_b32 v7, 0xffff0000, v59
    v_fmac_f32 v12, v113, v6
    v_fmac_f32 v13, v113, v7
    v_lshlrev_b32 v6, 16, v60
    v_and_b32 v7, 0xffff0000, v60
    v_fmac_f32 v14, v113, v6
    v_fmac_f32 v15, v113, v7
    v_lshlrev_b32 v6, 16, v61
    v_and_b32 v7, 0xffff0000, v61
    v_fmac_f32 v16, v113, v6
    v_fmac_f32 v17, v113, v7
    v_lshlrev_b32 v6, 16, v62
    v_and_b32 v7, 0xffff0000, v62
    v_fmac_f32 v18, v113, v6
    v_fmac_f32 v19, v113, v7
    v_lshlrev_b32 v6, 16, v63
    v_and_b32 v7, 0xffff0000, v63
    v_fmac_f32 v20, v113, v6
    v_fmac_f32 v21, v113, v7
    v_lshlrev_b32 v6, 16, v64
    v_and_b32 v7, 0xffff0000, v64
    v_fmac_f32 v22, v113, v6
    v_fmac_f32 v23, v113, v7
    v_lshlrev_b32 v6, 16, v65
    v_and_b32 v7, 0xffff0000, v65
    v_fmac_f32 v24, v113, v6
    v_fmac_f32 v25, v113, v7
    v_lshlrev_b32 v6, 16, v66
    v_and_b32 v7, 0xffff0000, v66
    v_fmac_f32 v26, v113, v6
    v_fmac_f32 v27, v113, v7
    v_lshlrev_b32 v6, 16, v67
    v_and_b32 v7, 0xffff0000, v67
    v_fmac_f32 v28, v113, v6
    v_fmac_f32 v29, v113, v7
    v_lshlrev_b32 v6, 16, v68
    v_and_b32 v7, 0xffff0000, v68
    v_fmac_f32 v30, v113, v6
    v_fmac_f32 v31, v113, v7
    v_lshlrev_b32 v6, 16, v69
    v_and_b32 v7, 0xffff0000, v69
    v_fmac_f32 v32, v113, v6
    v_fmac_f32 v33, v113, v7
    v_lshlrev_b32 v6, 16, v70
    v_and_b32 v7, 0xffff0000, v70
    v_fmac_f32 v34, v113, v6
    v_fmac_f32 v35, v113, v7
    v_lshlrev_b32 v6, 16, v71
    v_and_b32 v7, 0xffff0000, v71
    v_fmac_f32 v36, v113, v6
    v_fmac_f32 v37, v113, v7
    s_waitcnt vmcnt(7)
    v_lshlrev_b32 v6, 16, v72
    v_and_b32 v7, 0xffff0000, v72
    v_fmac_f32 v10, v114, v6
    v_fmac_f32 v11, v114, v7
    v_lshlrev_b32 v6, 16, v73
    v_and_b32 v7, 0xffff0000, v73
    v_fmac_f32 v12, v114, v6
    v_fmac_f32 v13, v114, v7
    v_lshlrev_b32 v6, 16, v74
    v_and_b32 v7, 0xffff0000, v74
    v_fmac_f32 v14, v114, v6
    v_fmac_f32 v15, v114, v7
    v_lshlrev_b32 v6, 16, v75
    v_and_b32 v7, 0xffff0000, v75
    v_fmac_f32 v16, v114, v6
    v_fmac_f32 v17, v114, v7
    v_lshlrev_b32 v6, 16, v76
    v_and_b32 v7, 0xffff0000, v76
    v_fmac_f32 v18, v114, v6
    v_fmac_f32 v19, v114, v7
    v_lshlrev_b32 v6, 16, v77
    v_and_b32 v7, 0xffff0000, v77
    v_fmac_f32 v20, v114, v6
    v_fmac_f32 v21, v114, v7
    v_lshlrev_b32 v6, 16, v78
    v_and_b32 v7, 0xffff0000, v78
    v_fmac_f32 v22, v114, v6
    v_fmac_f32 v23, v114, v7
    v_lshlrev_b32 v6, 16, v79
    v_and_b32 v7, 0xffff0000, v79
    v_fmac_f32 v24, v114, v6
    v_fmac_f32 v25, v114, v7
    v_lshlrev_b32 v6, 16, v80
    v_and_b32 v7, 0xffff0000, v80
    v_fmac_f32 v26, v114, v6
    v_fmac_f32 v27, v114, v7
    v_lshlrev_b32 v6, 16, v81
    v_and_b32 v7, 0xffff0000, v81
    v_fmac_f32 v28, v114, v6
    v_fmac_f32 v29, v114, v7
    v_lshlrev_b32 v6, 16, v82
    v_and_b32 v7, 0xffff0000, v82
    v_fmac_f32 v30, v114, v6
    v_fmac_f32 v31, v114, v7
    v_lshlrev_b32 v6, 16, v83
    v_and_b32 v7, 0xffff0000, v83
    v_fmac_f32 v32, v114, v6
    v_fmac_f32 v33, v114, v7
    v_lshlrev_b32 v6, 16, v84
    v_and_b32 v7, 0xffff0000, v84
    v_fmac_f32 v34, v114, v6
    v_fmac_f32 v35, v114, v7
    v_lshlrev_b32 v6, 16, v85
    v_and_b32 v7, 0xffff0000, v85
    v_fmac_f32 v36, v114, v6
    v_fmac_f32 v37, v114, v7
    s_waitcnt vmcnt(0)
    v_lshlrev_b32 v6, 16, v86
    v_and_b32 v7, 0xffff0000, v86
    v_fmac_f32 v10, v115, v6
    v_fmac_f32 v11, v115, v7
    v_lshlrev_b32 v6, 16, v87
    v_and_b32 v7, 0xffff0000, v87
    v_fmac_f32 v12, v115, v6
    v_fmac_f32 v13, v115, v7
    v_lshlrev_b32 v6, 16, v88
    v_and_b32 v7, 0xffff0000, v88
    v_fmac_f32 v14, v115, v6
    v_fmac_f32 v15, v115, v7
    v_lshlrev_b32 v6, 16, v89
    v_and_b32 v7, 0xffff0000, v89
    v_fmac_f32 v16, v115, v6
    v_fmac_f32 v17, v115, v7
    v_lshlrev_b32 v6, 16, v90
    v_and_b32 v7, 0xffff0000, v90
    v_fmac_f32 v18, v115, v6
    v_fmac_f32 v19, v115, v7
    v_lshlrev_b32 v6, 16, v91
    v_and_b32 v7, 0xffff0000, v91
    v_fmac_f32 v20, v115, v6
    v_fmac_f32 v21, v115, v7
    v_lshlrev_b32 v6, 16, v92
    v_and_b32 v7, 0xffff0000, v92
    v_fmac_f32 v22, v115, v6
    v_fmac_f32 v23, v115, v7
    v_lshlrev_b32 v6, 16, v93
    v_and_b32 v7, 0xffff0000, v93
    v_fmac_f32 v24, v115, v6
    v_fmac_f32 v25, v115, v7
    v_lshlrev_b32 v6, 16, v94
    v_and_b32 v7, 0xffff0000, v94
    v_fmac_f32 v26, v115, v6
    v_fmac_f32 v27, v115, v7
    v_lshlrev_b32 v6, 16, v95
    v_and_b32 v7, 0xffff0000, v95
    v_fmac_f32 v28, v115, v6
    v_fmac_f32 v29, v115, v7
    v_lshlrev_b32 v6, 16, v96
    v_and_b32 v7, 0xffff0000, v96
    v_fmac_f32 v30, v115, v6
    v_fmac_f32 v31, v115, v7
    v_lshlrev_b32 v6, 16, v97
    v_and_b32 v7, 0xffff0000, v97
    v_fmac_f32 v32, v115, v6
    v_fmac_f32 v33, v115, v7
    v_lshlrev_b32 v6, 16, v98
    v_and_b32 v7, 0xffff0000, v98
    v_fmac_f32 v34, v115, v6
    v_fmac_f32 v35, v115, v7
    v_lshlrev_b32 v6, 16, v99
    v_and_b32 v7, 0xffff0000, v99
    v_fmac_f32 v36, v115, v6
    v_fmac_f32 v37, v115, v7
    s_mov_b32 s40, 896
    v_mul_lo_u32 v4, v2, s40
    v_add_u32 v4, v4, v3
    v_cvt_pk_bf16_f32 v44, v10, v11
    v_cvt_pk_bf16_f32 v45, v12, v13
    v_cvt_pk_bf16_f32 v46, v14, v15
    v_cvt_pk_bf16_f32 v47, v16, v17
    v_cvt_pk_bf16_f32 v48, v18, v19
    v_cvt_pk_bf16_f32 v49, v20, v21
    v_cvt_pk_bf16_f32 v50, v22, v23
    v_cvt_pk_bf16_f32 v51, v24, v25
    v_cvt_pk_bf16_f32 v52, v26, v27
    v_cvt_pk_bf16_f32 v53, v28, v29
    v_cvt_pk_bf16_f32 v54, v30, v31
    v_cvt_pk_bf16_f32 v55, v32, v33
    v_cvt_pk_bf16_f32 v56, v34, v35
    v_cvt_pk_bf16_f32 v57, v36, v37
    buffer_store_dwordx2 v[44:45], v4, s[32:35], 0 offen offset:0
    buffer_store_dwordx2 v[46:47], v4, s[32:35], 0 offen offset:8
    buffer_store_dwordx2 v[48:49], v4, s[32:35], 0 offen offset:16
    buffer_store_dwordx2 v[50:51], v4, s[32:35], 0 offen offset:24
    buffer_store_dwordx2 v[52:53], v4, s[32:35], 0 offen offset:32
    buffer_store_dwordx2 v[54:55], v4, s[32:35], 0 offen offset:40
    buffer_store_dwordx2 v[56:57], v4, s[32:35], 0 offen offset:48
k2_exit:
    s_endpgm
.section .rodata,"a"
.p2align 6
.amdhsa_kernel k2_attn_kernel
  .amdhsa_next_free_vgpr 136
  .amdhsa_next_free_sgpr 96
  .amdhsa_accum_offset 136
  .amdhsa_group_segment_fixed_size 0
  .amdhsa_kernarg_size 88
  .amdhsa_user_sgpr_count 2
  .amdhsa_user_sgpr_kernarg_segment_ptr 1
  .amdhsa_system_sgpr_workgroup_id_x 1
.end_amdhsa_kernel
.text
.globl k3_out_kernel
.p2align 8
.type k3_out_kernel,@function
k3_out_kernel:
    s_cmp_ge_u32 s2, 128
    s_cbranch_scc1 k3_exit
    s_load_dwordx2 s[4:5], s[0:1], 32
    s_load_dwordx2 s[6:7], s[0:1], 56
    s_load_dwordx2 s[8:9], s[0:1], 64
    s_load_dwordx2 s[20:21], s[0:1], 80
    s_and_b32 s22, s2, 3
    s_lshr_b32 s23, s2, 3
    s_lshl_b32 s41, s23, 7
    s_lshl_b32 s38, s22, 7
    s_mov_b32 s36, 896
    s_mov_b32 s37, 1792
    s_mov_b32 s39, 448
    s_waitcnt lgkmcnt(0)
    s_bitcmp1_b32 s2, 2
    s_cbranch_scc1 k3_b
    s_add_u32 s24, s20, 0x900000
    s_addc_u32 s25, s21, 0
    s_and_b32 s25, s25, 0xffff
    s_mov_b32 s26, 0x1c0000
    s_mov_b32 s27, 0x00020000
    s_add_u32 s28, s4, 0x0
    s_addc_u32 s29, s5, 0
    s_and_b32 s29, s29, 0xffff
    s_mov_b32 s30, 0x62000
    s_mov_b32 s31, 0x00020000
    s_add_u32 s32, s8, 0x0
    s_addc_u32 s33, s9, 0
    s_and_b32 s33, s33, 0xffff
    s_mov_b32 s34, 0x380000
    s_mov_b32 s35, 0x00020000
    s_branch k3_main
k3_b:
    s_add_u32 s24, s20, 0xb00000
    s_addc_u32 s25, s21, 0
    s_and_b32 s25, s25, 0xffff
    s_mov_b32 s26, 0x1c0000
    s_mov_b32 s27, 0x00020000
    s_add_u32 s28, s6, 0x0
    s_addc_u32 s29, s7, 0
    s_and_b32 s29, s29, 0xffff
    s_mov_b32 s30, 0x62000
    s_mov_b32 s31, 0x00020000
    s_add_u32 s32, s8, 0x380
    s_addc_u32 s33, s9, 0
    s_and_b32 s33, s33, 0xffff
    s_mov_b32 s34, 0x37fc80
    s_mov_b32 s35, 0x00020000
k3_main:
    v_lshrrev_b32 v7, 5, v0
    v_and_b32 v8, 31, v0
    v_add_u32 v9, s41, v7
    s_mov_b32 s40, 896
    v_mul_lo_u32 v1, v9, s40
    v_lshl_add_u32 v1, v8, 4, v1
    s_mov_b32 s40, 464
    v_mul_lo_u32 v2, v7, s40
    v_lshl_add_u32 v2, v8, 4, v2
    v_cmp_gt_u32 s[42:43], 28, v8
    v_lshrrev_b32 v7, 4, v0
    v_and_b32 v8, 15, v0
    s_mov_b32 s40, 272
    v_mul_lo_u32 v4, v7, s40
    v_mul_lo_u32 v3, v7, s36
    v_lshl_add_u32 v3, v8, 4, v3
    s_lshl_b32 s40, s38, 1
    v_add_u32 v3, s40, v3
    v_lshl_add_u32 v4, v8, 4, v4
    v_add_u32 v4, 59392, v4
    s_mov_b32 s40, 0
    buffer_load_dwordx4 v[16:19], v1, s[24:27], s40 offen
    s_mov_b32 s40, 7168
    buffer_load_dwordx4 v[20:23], v1, s[24:27], s40 offen
    s_mov_b32 s40, 14336
    buffer_load_dwordx4 v[24:27], v1, s[24:27], s40 offen
    s_mov_b32 s40, 21504
    buffer_load_dwordx4 v[28:31], v1, s[24:27], s40 offen
    s_mov_b32 s40, 28672
    buffer_load_dwordx4 v[32:35], v1, s[24:27], s40 offen
    s_mov_b32 s40, 35840
    buffer_load_dwordx4 v[36:39], v1, s[24:27], s40 offen
    s_mov_b32 s40, 43008
    buffer_load_dwordx4 v[40:43], v1, s[24:27], s40 offen
    s_mov_b32 s40, 50176
    buffer_load_dwordx4 v[44:47], v1, s[24:27], s40 offen
    s_mov_b32 s40, 57344
    buffer_load_dwordx4 v[48:51], v1, s[24:27], s40 offen
    s_mov_b32 s40, 64512
    buffer_load_dwordx4 v[52:55], v1, s[24:27], s40 offen
    s_mov_b32 s40, 71680
    buffer_load_dwordx4 v[56:59], v1, s[24:27], s40 offen
    s_mov_b32 s40, 78848
    buffer_load_dwordx4 v[60:63], v1, s[24:27], s40 offen
    s_mov_b32 s40, 86016
    buffer_load_dwordx4 v[64:67], v1, s[24:27], s40 offen
    s_mov_b32 s40, 93184
    buffer_load_dwordx4 v[68:71], v1, s[24:27], s40 offen
    s_mov_b32 s40, 100352
    buffer_load_dwordx4 v[72:75], v1, s[24:27], s40 offen
    s_mov_b32 s40, 107520
    buffer_load_dwordx4 v[76:79], v1, s[24:27], s40 offen
    s_mul_i32 s40, s36, 0
    buffer_load_dwordx4 v[80:83], v3, s[28:31], s40 offen
    s_mul_i32 s40, s36, 16
    buffer_load_dwordx4 v[84:87], v3, s[28:31], s40 offen
    s_mul_i32 s40, s36, 32
    buffer_load_dwordx4 v[88:91], v3, s[28:31], s40 offen
    s_mul_i32 s40, s36, 48
    buffer_load_dwordx4 v[92:95], v3, s[28:31], s40 offen
    s_mul_i32 s40, s36, 64
    buffer_load_dwordx4 v[96:99], v3, s[28:31], s40 offen
    s_mul_i32 s40, s36, 80
    buffer_load_dwordx4 v[100:103], v3, s[28:31], s40 offen
    s_mul_i32 s40, s36, 96
    buffer_load_dwordx4 v[104:107], v3, s[28:31], s40 offen
    s_mul_i32 s40, s36, 112
    buffer_load_dwordx4 v[108:111], v3, s[28:31], s40 offen
    s_mul_i32 s40, s36, 128
    buffer_load_dwordx4 v[112:115], v3, s[28:31], s40 offen
    s_mul_i32 s40, s36, 144
    buffer_load_dwordx4 v[116:119], v3, s[28:31], s40 offen
    s_mul_i32 s40, s36, 160
    buffer_load_dwordx4 v[120:123], v3, s[28:31], s40 offen
    s_mul_i32 s40, s36, 176
    buffer_load_dwordx4 v[124:127], v3, s[28:31], s40 offen
    s_mul_i32 s40, s36, 192
    buffer_load_dwordx4 v[128:131], v3, s[28:31], s40 offen
    s_mul_i32 s40, s36, 208
    buffer_load_dwordx4 v[132:135], v3, s[28:31], s40 offen
    v_lshrrev_b32 v7, 6, v0
    v_and_b32 v8, 63, v0
    v_and_b32 v9, 31, v8
    v_lshrrev_b32 v10, 5, v8
    v_lshrrev_b32 v11, 1, v7
    v_and_b32 v12, 1, v7
    v_lshl_add_u32 v13, v11, 6, v9
    s_mov_b32 s40, 464
    v_mul_lo_u32 v5, v13, s40
    v_lshl_add_u32 v5, v10, 4, v5
    v_bfe_u32 v14, v8, 2, 2
    v_lshl_add_u32 v14, v10, 3, v14
    s_mov_b32 s40, 272
    v_mul_lo_u32 v6, v14, s40
    v_bfe_u32 v14, v8, 4, 1
    v_lshlrev_b32 v14, 5, v14
    v_lshl_add_u32 v14, v12, 7, v14
    v_and_b32 v15, 3, v8
    v_lshl_add_u32 v14, v15, 3, v14
    v_add_u32 v6, v6, v14
    v_add_u32 v6, 59392, v6
    v_mov_b32 v136, 0
    v_mov_b32 v137, 0
    v_mov_b32 v138, 0
    v_mov_b32 v139, 0
    v_mov_b32 v140, 0
    v_mov_b32 v141, 0
    v_mov_b32 v142, 0
    v_mov_b32 v143, 0
    v_mov_b32 v144, 0
    v_mov_b32 v145, 0
    v_mov_b32 v146, 0
    v_mov_b32 v147, 0
    v_mov_b32 v148, 0
    v_mov_b32 v149, 0
    v_mov_b32 v150, 0
    v_mov_b32 v151, 0
    v_mov_b32 v152, 0
    v_mov_b32 v153, 0
    v_mov_b32 v154, 0
    v_mov_b32 v155, 0
    v_mov_b32 v156, 0
    v_mov_b32 v157, 0
    v_mov_b32 v158, 0
    v_mov_b32 v159, 0
    v_mov_b32 v160, 0
    v_mov_b32 v161, 0
    v_mov_b32 v162, 0
    v_mov_b32 v163, 0
    v_mov_b32 v164, 0
    v_mov_b32 v165, 0
    v_mov_b32 v166, 0
    v_mov_b32 v167, 0
    v_mov_b32 v168, 0
    v_mov_b32 v169, 0
    v_mov_b32 v170, 0
    v_mov_b32 v171, 0
    v_mov_b32 v172, 0
    v_mov_b32 v173, 0
    v_mov_b32 v174, 0
    v_mov_b32 v175, 0
    v_mov_b32 v176, 0
    v_mov_b32 v177, 0
    v_mov_b32 v178, 0
    v_mov_b32 v179, 0
    v_mov_b32 v180, 0
    v_mov_b32 v181, 0
    v_mov_b32 v182, 0
    v_mov_b32 v183, 0
    v_mov_b32 v184, 0
    v_mov_b32 v185, 0
    v_mov_b32 v186, 0
    v_mov_b32 v187, 0
    v_mov_b32 v188, 0
    v_mov_b32 v189, 0
    v_mov_b32 v190, 0
    v_mov_b32 v191, 0
    v_mov_b32 v192, 0
    v_mov_b32 v193, 0
    v_mov_b32 v194, 0
    v_mov_b32 v195, 0
    v_mov_b32 v196, 0
    v_mov_b32 v197, 0
    v_mov_b32 v198, 0
    v_mov_b32 v199, 0
    s_waitcnt vmcnt(0)
    s_mov_b64 exec, s[42:43]
    ds_write_b128 v2, v[16:19] offset:0
    ds_write_b128 v2, v[20:23] offset:3712
    ds_write_b128 v2, v[24:27] offset:7424
    ds_write_b128 v2, v[28:31] offset:11136
    ds_write_b128 v2, v[32:35] offset:14848
    ds_write_b128 v2, v[36:39] offset:18560
    ds_write_b128 v2, v[40:43] offset:22272
    ds_write_b128 v2, v[44:47] offset:25984
    ds_write_b128 v2, v[48:51] offset:29696
    ds_write_b128 v2, v[52:55] offset:33408
    ds_write_b128 v2, v[56:59] offset:37120
    ds_write_b128 v2, v[60:63] offset:40832
    ds_write_b128 v2, v[64:67] offset:44544
    ds_write_b128 v2, v[68:71] offset:48256
    ds_write_b128 v2, v[72:75] offset:51968
    ds_write_b128 v2, v[76:79] offset:55680
    s_mov_b64 exec, -1
    ds_write_b128 v4, v[80:83] offset:0
    ds_write_b128 v4, v[84:87] offset:4352
    ds_write_b128 v4, v[88:91] offset:8704
    ds_write_b128 v4, v[92:95] offset:13056
    ds_write_b128 v4, v[96:99] offset:17408
    ds_write_b128 v4, v[100:103] offset:21760
    ds_write_b128 v4, v[104:107] offset:26112
    ds_write_b128 v4, v[108:111] offset:30464
    ds_write_b128 v4, v[112:115] offset:34816
    ds_write_b128 v4, v[116:119] offset:39168
    ds_write_b128 v4, v[120:123] offset:43520
    ds_write_b128 v4, v[124:127] offset:47872
    ds_write_b128 v4, v[128:131] offset:52224
    ds_write_b128 v4, v[132:135] offset:56576
    s_waitcnt lgkmcnt(0)
    s_barrier
    s_mov_b32 s40, 448
    buffer_load_dwordx4 v[16:19], v1, s[24:27], s40 offen
    s_mov_b32 s40, 7616
    buffer_load_dwordx4 v[20:23], v1, s[24:27], s40 offen
    s_mov_b32 s40, 14784
    buffer_load_dwordx4 v[24:27], v1, s[24:27], s40 offen
    s_mov_b32 s40, 21952
    buffer_load_dwordx4 v[28:31], v1, s[24:27], s40 offen
    s_mov_b32 s40, 29120
    buffer_load_dwordx4 v[32:35], v1, s[24:27], s40 offen
    s_mov_b32 s40, 36288
    buffer_load_dwordx4 v[36:39], v1, s[24:27], s40 offen
    s_mov_b32 s40, 43456
    buffer_load_dwordx4 v[40:43], v1, s[24:27], s40 offen
    s_mov_b32 s40, 50624
    buffer_load_dwordx4 v[44:47], v1, s[24:27], s40 offen
    s_mov_b32 s40, 57792
    buffer_load_dwordx4 v[48:51], v1, s[24:27], s40 offen
    s_mov_b32 s40, 64960
    buffer_load_dwordx4 v[52:55], v1, s[24:27], s40 offen
    s_mov_b32 s40, 72128
    buffer_load_dwordx4 v[56:59], v1, s[24:27], s40 offen
    s_mov_b32 s40, 79296
    buffer_load_dwordx4 v[60:63], v1, s[24:27], s40 offen
    s_mov_b32 s40, 86464
    buffer_load_dwordx4 v[64:67], v1, s[24:27], s40 offen
    s_mov_b32 s40, 93632
    buffer_load_dwordx4 v[68:71], v1, s[24:27], s40 offen
    s_mov_b32 s40, 100800
    buffer_load_dwordx4 v[72:75], v1, s[24:27], s40 offen
    s_mov_b32 s40, 107968
    buffer_load_dwordx4 v[76:79], v1, s[24:27], s40 offen
    s_mul_i32 s40, s36, 224
    buffer_load_dwordx4 v[80:83], v3, s[28:31], s40 offen
    s_mul_i32 s40, s36, 240
    buffer_load_dwordx4 v[84:87], v3, s[28:31], s40 offen
    s_mul_i32 s40, s36, 256
    buffer_load_dwordx4 v[88:91], v3, s[28:31], s40 offen
    s_mul_i32 s40, s36, 272
    buffer_load_dwordx4 v[92:95], v3, s[28:31], s40 offen
    s_mul_i32 s40, s36, 288
    buffer_load_dwordx4 v[96:99], v3, s[28:31], s40 offen
    s_mul_i32 s40, s36, 304
    buffer_load_dwordx4 v[100:103], v3, s[28:31], s40 offen
    s_mul_i32 s40, s36, 320
    buffer_load_dwordx4 v[104:107], v3, s[28:31], s40 offen
    s_mul_i32 s40, s36, 336
    buffer_load_dwordx4 v[108:111], v3, s[28:31], s40 offen
    s_mul_i32 s40, s36, 352
    buffer_load_dwordx4 v[112:115], v3, s[28:31], s40 offen
    s_mul_i32 s40, s36, 368
    buffer_load_dwordx4 v[116:119], v3, s[28:31], s40 offen
    s_mul_i32 s40, s36, 384
    buffer_load_dwordx4 v[120:123], v3, s[28:31], s40 offen
    s_mul_i32 s40, s36, 400
    buffer_load_dwordx4 v[124:127], v3, s[28:31], s40 offen
    s_mul_i32 s40, s36, 416
    buffer_load_dwordx4 v[128:131], v3, s[28:31], s40 offen
    s_mul_i32 s40, s36, 432
    buffer_load_dwordx4 v[132:135], v3, s[28:31], s40 offen
    v_mov_b32 v232, v5
    v_mov_b32 v233, v6
    s_mov_b32 s50, 0
    ds_read_b128 v[200:203], v232 offset:0
    ds_read_b128 v[204:207], v232 offset:14848
    ds_read_b64_tr_b16 v[208:209], v233 offset:0
    ds_read_b64_tr_b16 v[210:211], v233 offset:1088
    ds_read_b64_tr_b16 v[212:213], v233 offset:64
    ds_read_b64_tr_b16 v[214:215], v233 offset:1152
gk5:
    ds_read_b128 v[216:219], v232 offset:32
    ds_read_b128 v[220:223], v232 offset:14880
    ds_read_b64_tr_b16 v[224:225], v233 offset:4352
    ds_read_b64_tr_b16 v[226:227], v233 offset:5440
    ds_read_b64_tr_b16 v[228:229], v233 offset:4416
    ds_read_b64_tr_b16 v[230:231], v233 offset:5504
    s_waitcnt lgkmcnt(6)
    v_mfma_f32_32x32x16_bf16 v[136:151], v[208:211], v[200:203], v[136:151]
    v_mfma_f32_32x32x16_bf16 v[152:167], v[212:215], v[200:203], v[152:167]
    v_mfma_f32_32x32x16_bf16 v[168:183], v[208:211], v[204:207], v[168:183]
    v_mfma_f32_32x32x16_bf16 v[184:199], v[212:215], v[204:207], v[184:199]
    ds_read_b128 v[200:203], v232 offset:64
    ds_read_b128 v[204:207], v232 offset:14912
    ds_read_b64_tr_b16 v[208:209], v233 offset:8704
    ds_read_b64_tr_b16 v[210:211], v233 offset:9792
    ds_read_b64_tr_b16 v[212:213], v233 offset:8768
    ds_read_b64_tr_b16 v[214:215], v233 offset:9856
    s_waitcnt lgkmcnt(6)
    v_mfma_f32_32x32x16_bf16 v[136:151], v[224:227], v[216:219], v[136:151]
    v_mfma_f32_32x32x16_bf16 v[152:167], v[228:231], v[216:219], v[152:167]
    v_mfma_f32_32x32x16_bf16 v[168:183], v[224:227], v[220:223], v[168:183]
    v_mfma_f32_32x32x16_bf16 v[184:199], v[228:231], v[220:223], v[184:199]
    v_add_u32 v232, 64, v232
    v_add_u32 v233, 8704, v233
    s_add_u32 s50, s50, 1
    s_cmp_lt_u32 s50, 7
    s_cbranch_scc1 gk5
    s_waitcnt lgkmcnt(0)
    s_barrier
    s_waitcnt vmcnt(0)
    s_mov_b64 exec, s[42:43]
    ds_write_b128 v2, v[16:19] offset:0
    ds_write_b128 v2, v[20:23] offset:3712
    ds_write_b128 v2, v[24:27] offset:7424
    ds_write_b128 v2, v[28:31] offset:11136
    ds_write_b128 v2, v[32:35] offset:14848
    ds_write_b128 v2, v[36:39] offset:18560
    ds_write_b128 v2, v[40:43] offset:22272
    ds_write_b128 v2, v[44:47] offset:25984
    ds_write_b128 v2, v[48:51] offset:29696
    ds_write_b128 v2, v[52:55] offset:33408
    ds_write_b128 v2, v[56:59] offset:37120
    ds_write_b128 v2, v[60:63] offset:40832
    ds_write_b128 v2, v[64:67] offset:44544
    ds_write_b128 v2, v[68:71] offset:48256
    ds_write_b128 v2, v[72:75] offset:51968
    ds_write_b128 v2, v[76:79] offset:55680
    s_mov_b64 exec, -1
    ds_write_b128 v4, v[80:83] offset:0
    ds_write_b128 v4, v[84:87] offset:4352
    ds_write_b128 v4, v[88:91] offset:8704
    ds_write_b128 v4, v[92:95] offset:13056
    ds_write_b128 v4, v[96:99] offset:17408
    ds_write_b128 v4, v[100:103] offset:21760
    ds_write_b128 v4, v[104:107] offset:26112
    ds_write_b128 v4, v[108:111] offset:30464
    ds_write_b128 v4, v[112:115] offset:34816
    ds_write_b128 v4, v[116:119] offset:39168
    ds_write_b128 v4, v[120:123] offset:43520
    ds_write_b128 v4, v[124:127] offset:47872
    ds_write_b128 v4, v[128:131] offset:52224
    ds_write_b128 v4, v[132:135] offset:56576
    s_waitcnt lgkmcnt(0)
    s_barrier
    v_mov_b32 v232, v5
    v_mov_b32 v233, v6
    s_mov_b32 s50, 0
    ds_read_b128 v[200:203], v232 offset:0
    ds_read_b128 v[204:207], v232 offset:14848
    ds_read_b64_tr_b16 v[208:209], v233 offset:0
    ds_read_b64_tr_b16 v[210:211], v233 offset:1088
    ds_read_b64_tr_b16 v[212:213], v233 offset:64
    ds_read_b64_tr_b16 v[214:215], v233 offset:1152
gk6:
    ds_read_b128 v[216:219], v232 offset:32
    ds_read_b128 v[220:223], v232 offset:14880
    ds_read_b64_tr_b16 v[224:225], v233 offset:4352
    ds_read_b64_tr_b16 v[226:227], v233 offset:5440
    ds_read_b64_tr_b16 v[228:229], v233 offset:4416
    ds_read_b64_tr_b16 v[230:231], v233 offset:5504
    s_waitcnt lgkmcnt(6)
    v_mfma_f32_32x32x16_bf16 v[136:151], v[208:211], v[200:203], v[136:151]
    v_mfma_f32_32x32x16_bf16 v[152:167], v[212:215], v[200:203], v[152:167]
    v_mfma_f32_32x32x16_bf16 v[168:183], v[208:211], v[204:207], v[168:183]
    v_mfma_f32_32x32x16_bf16 v[184:199], v[212:215], v[204:207], v[184:199]
    ds_read_b128 v[200:203], v232 offset:64
    ds_read_b128 v[204:207], v232 offset:14912
    ds_read_b64_tr_b16 v[208:209], v233 offset:8704
    ds_read_b64_tr_b16 v[210:211], v233 offset:9792
    ds_read_b64_tr_b16 v[212:213], v233 offset:8768
    ds_read_b64_tr_b16 v[214:215], v233 offset:9856
    s_waitcnt lgkmcnt(6)
    v_mfma_f32_32x32x16_bf16 v[136:151], v[224:227], v[216:219], v[136:151]
    v_mfma_f32_32x32x16_bf16 v[152:167], v[228:231], v[216:219], v[152:167]
    v_mfma_f32_32x32x16_bf16 v[168:183], v[224:227], v[220:223], v[168:183]
    v_mfma_f32_32x32x16_bf16 v[184:199], v[228:231], v[220:223], v[184:199]
    v_add_u32 v232, 64, v232
    v_add_u32 v233, 8704, v233
    s_add_u32 s50, s50, 1
    s_cmp_lt_u32 s50, 7
    s_cbranch_scc1 gk6
    s_waitcnt lgkmcnt(0)
    s_nop 15
    s_nop 3
    v_add_u32 v16, s41, v13
    v_mul_lo_u32 v16, v16, s37
    v_lshlrev_b32 v17, 6, v12
    v_lshl_add_u32 v17, v10, 2, v17
    v_add_u32 v17, s38, v17
    v_lshl_add_u32 v16, v17, 1, v16
    s_lshl_b32 s40, s37, 5
    v_cvt_pk_bf16_f32 v20, v136, v137
    v_cvt_pk_bf16_f32 v21, v138, v139
    v_add_u32 v18, 0, v17
    v_cmp_gt_u32 vcc, s39, v18
    v_mov_b32 v19, 0x40000000
    s_nop 1
    v_cndmask_b32 v19, v19, v16, vcc
    buffer_store_dwordx2 v[20:21], v19, s[32:35], 0 offen offset:0
    s_nop 1
    v_cvt_pk_bf16_f32 v20, v140, v141
    v_cvt_pk_bf16_f32 v21, v142, v143
    v_add_u32 v18, 8, v17
    v_cmp_gt_u32 vcc, s39, v18
    v_mov_b32 v19, 0x40000000
    s_nop 1
    v_cndmask_b32 v19, v19, v16, vcc
    buffer_store_dwordx2 v[20:21], v19, s[32:35], 0 offen offset:16
    s_nop 1
    v_cvt_pk_bf16_f32 v20, v144, v145
    v_cvt_pk_bf16_f32 v21, v146, v147
    v_add_u32 v18, 16, v17
    v_cmp_gt_u32 vcc, s39, v18
    v_mov_b32 v19, 0x40000000
    s_nop 1
    v_cndmask_b32 v19, v19, v16, vcc
    buffer_store_dwordx2 v[20:21], v19, s[32:35], 0 offen offset:32
    s_nop 1
    v_cvt_pk_bf16_f32 v20, v148, v149
    v_cvt_pk_bf16_f32 v21, v150, v151
    v_add_u32 v18, 24, v17
    v_cmp_gt_u32 vcc, s39, v18
    v_mov_b32 v19, 0x40000000
    s_nop 1
    v_cndmask_b32 v19, v19, v16, vcc
    buffer_store_dwordx2 v[20:21], v19, s[32:35], 0 offen offset:48
    s_nop 1
    v_cvt_pk_bf16_f32 v20, v152, v153
    v_cvt_pk_bf16_f32 v21, v154, v155
    v_add_u32 v18, 32, v17
    v_cmp_gt_u32 vcc, s39, v18
    v_mov_b32 v19, 0x40000000
    s_nop 1
    v_cndmask_b32 v19, v19, v16, vcc
    buffer_store_dwordx2 v[20:21], v19, s[32:35], 0 offen offset:64
    s_nop 1
    v_cvt_pk_bf16_f32 v20, v156, v157
    v_cvt_pk_bf16_f32 v21, v158, v159
    v_add_u32 v18, 40, v17
    v_cmp_gt_u32 vcc, s39, v18
    v_mov_b32 v19, 0x40000000
    s_nop 1
    v_cndmask_b32 v19, v19, v16, vcc
    buffer_store_dwordx2 v[20:21], v19, s[32:35], 0 offen offset:80
    s_nop 1
    v_cvt_pk_bf16_f32 v20, v160, v161
    v_cvt_pk_bf16_f32 v21, v162, v163
    v_add_u32 v18, 48, v17
    v_cmp_gt_u32 vcc, s39, v18
    v_mov_b32 v19, 0x40000000
    s_nop 1
    v_cndmask_b32 v19, v19, v16, vcc
    buffer_store_dwordx2 v[20:21], v19, s[32:35], 0 offen offset:96
    s_nop 1
    v_cvt_pk_bf16_f32 v20, v164, v165
    v_cvt_pk_bf16_f32 v21, v166, v167
    v_add_u32 v18, 56, v17
    v_cmp_gt_u32 vcc, s39, v18
    v_mov_b32 v19, 0x40000000
    s_nop 1
    v_cndmask_b32 v19, v19, v16, vcc
    buffer_store_dwordx2 v[20:21], v19, s[32:35], 0 offen offset:112
    s_nop 1
    v_cvt_pk_bf16_f32 v20, v168, v169
    v_cvt_pk_bf16_f32 v21, v170, v171
    v_add_u32 v18, 0, v17
    v_cmp_gt_u32 vcc, s39, v18
    v_mov_b32 v19, 0x40000000
    s_nop 1
    v_cndmask_b32 v19, v19, v16, vcc
    buffer_store_dwordx2 v[20:21], v19, s[32:35], s40 offen offset:0
    s_nop 1
    v_cvt_pk_bf16_f32 v20, v172, v173
    v_cvt_pk_bf16_f32 v21, v174, v175
    v_add_u32 v18, 8, v17
    v_cmp_gt_u32 vcc, s39, v18
    v_mov_b32 v19, 0x40000000
    s_nop 1
    v_cndmask_b32 v19, v19, v16, vcc
    buffer_store_dwordx2 v[20:21], v19, s[32:35], s40 offen offset:16
    s_nop 1
    v_cvt_pk_bf16_f32 v20, v176, v177
    v_cvt_pk_bf16_f32 v21, v178, v179
    v_add_u32 v18, 16, v17
    v_cmp_gt_u32 vcc, s39, v18
    v_mov_b32 v19, 0x40000000
    s_nop 1
    v_cndmask_b32 v19, v19, v16, vcc
    buffer_store_dwordx2 v[20:21], v19, s[32:35], s40 offen offset:32
    s_nop 1
    v_cvt_pk_bf16_f32 v20, v180, v181
    v_cvt_pk_bf16_f32 v21, v182, v183
    v_add_u32 v18, 24, v17
    v_cmp_gt_u32 vcc, s39, v18
    v_mov_b32 v19, 0x40000000
    s_nop 1
    v_cndmask_b32 v19, v19, v16, vcc
    buffer_store_dwordx2 v[20:21], v19, s[32:35], s40 offen offset:48
    s_nop 1
    v_cvt_pk_bf16_f32 v20, v184, v185
    v_cvt_pk_bf16_f32 v21, v186, v187
    v_add_u32 v18, 32, v17
    v_cmp_gt_u32 vcc, s39, v18
    v_mov_b32 v19, 0x40000000
    s_nop 1
    v_cndmask_b32 v19, v19, v16, vcc
    buffer_store_dwordx2 v[20:21], v19, s[32:35], s40 offen offset:64
    s_nop 1
    v_cvt_pk_bf16_f32 v20, v188, v189
    v_cvt_pk_bf16_f32 v21, v190, v191
    v_add_u32 v18, 40, v17
    v_cmp_gt_u32 vcc, s39, v18
    v_mov_b32 v19, 0x40000000
    s_nop 1
    v_cndmask_b32 v19, v19, v16, vcc
    buffer_store_dwordx2 v[20:21], v19, s[32:35], s40 offen offset:80
    s_nop 1
    v_cvt_pk_bf16_f32 v20, v192, v193
    v_cvt_pk_bf16_f32 v21, v194, v195
    v_add_u32 v18, 48, v17
    v_cmp_gt_u32 vcc, s39, v18
    v_mov_b32 v19, 0x40000000
    s_nop 1
    v_cndmask_b32 v19, v19, v16, vcc
    buffer_store_dwordx2 v[20:21], v19, s[32:35], s40 offen offset:96
    s_nop 1
    v_cvt_pk_bf16_f32 v20, v196, v197
    v_cvt_pk_bf16_f32 v21, v198, v199
    v_add_u32 v18, 56, v17
    v_cmp_gt_u32 vcc, s39, v18
    v_mov_b32 v19, 0x40000000
    s_nop 1
    v_cndmask_b32 v19, v19, v16, vcc
    buffer_store_dwordx2 v[20:21], v19, s[32:35], s40 offen offset:112
    s_nop 1
    s_endpgm
k3_exit:
    s_endpgm
.section .rodata,"a"
.p2align 6
.amdhsa_kernel k3_out_kernel
  .amdhsa_next_free_vgpr 256
  .amdhsa_next_free_sgpr 96
  .amdhsa_accum_offset 256
  .amdhsa_group_segment_fixed_size 0
  .amdhsa_kernarg_size 88
  .amdhsa_user_sgpr_count 2
  .amdhsa_user_sgpr_kernarg_segment_ptr 1
  .amdhsa_system_sgpr_workgroup_id_x 1
.end_amdhsa_kernel
.text
```
